```python
import torch

def _softmax(x, axis=-1):
    return torch.softmax(x, dim=axis)

def _gelu(x):
    return torch.nn.functional.gelu(x, approximate='tanh')

def _silu(x):
    return torch.nn.functional.silu(x)

def _sigmoid(x):
    return torch.sigmoid(x)

def _layernorm(x, axis=-1, eps=1e-05):
    m = x.mean(dim=axis, keepdim=True)
    v = x.var(dim=axis, keepdim=True, unbiased=False)
    return (x - m) / torch.sqrt(v + eps)

def _scatter_add(tgt, idx, src, axis=0):
    return tgt.clone().index_add_(axis, idx, src)

def _segment_sum(src, seg, n):
    out = torch.zeros((n,) + src.shape[1:], dtype=src.dtype)
    return out.index_add_(0, seg, src)

def _pad(x, pw):
    flat = tuple((v for pair in reversed(pw) for v in pair))
    return torch.nn.functional.pad(x, flat)
kernel_name = 'standalone__ragged_sequences_varlen_flash_attn__ragged'

def setup_inputs():

    _w = lambda a: (lambda t: t.to(torch.bfloat16) if t.is_floating_point() else t)(torch.as_tensor(a))
    cu = torch.tensor([0, 485, 1609, 2680, 3050, 3769, 5493, 6501, 7684], dtype=torch.int64)
    T = int(cu[-1])
    Hq, Hkv, D = (16, 8, 128)
    assert Hq % Hkv == 0
    return {'q': _w((lambda *s: torch.randn(*s, dtype=torch.bfloat16) * 0.8)(T, Hq, D)), 'k': _w((lambda *s: torch.randn(*s, dtype=torch.bfloat16) * 0.8)(T, Hkv, D)), 'v': _w((lambda *s: torch.randn(*s, dtype=torch.bfloat16) * 0.05)(T, Hkv, D)), 'cu': _w(cu)}

def reference(q, k, v, cu):
    T, Hq, D = q.shape
    Hkv = k.shape[1]
    rep = Hq // Hkv
    scale = D ** (-0.5)
    outs = []
    for i in range(len(cu) - 1):
        s, e = (int(cu[i]), int(cu[i + 1]))
        L = e - s
        qi = q[s:e].clone()
        ki = (lambda x, n, axis: torch.repeat_interleave(x, n, dim=axis))(k[s:e], rep, axis=1)
        vi = (lambda x, n, axis: torch.repeat_interleave(x, n, dim=axis))(v[s:e], rep, axis=1)
        logits = torch.einsum('qhd,khd->hqk', qi, ki) * scale
        ar = torch.arange(L)
        neg = (lambda x, dt: x.to(dt))(ar[None, :] > ar[:, None], logits.dtype) * -1000000000.0
        p = _softmax(logits + neg[None, :, :], axis=-1)
        outs.append(torch.einsum('hqk,khd->qhd', p, vi))
    return torch.concatenate(outs, axis=0)
```

```asm
; @launch grid=(1024,1,1) block=(256,1,1) lds=65536
.amdgcn_target "amdgcn-amd-amdhsa--gfx950"
.text
.globl standalone__ragged_sequences_varlen_flash_attn__ragged_kernel
.p2align 8
.type standalone__ragged_sequences_varlen_flash_attn__ragged_kernel,@function
standalone__ragged_sequences_varlen_flash_attn__ragged_kernel:
    s_load_dwordx8 s[48:55], s[0:1], 0
    s_load_dwordx2 s[56:57], s[0:1], 32
    s_and_b32 s41, s2, 7
    s_lshr_b32 s40, s2, 3
    s_waitcnt lgkmcnt(0)
    s_load_dwordx8 s[4:11], s[54:55], 0
    s_load_dword s12, s[54:55], 32
    s_mov_b32 s16, s48
    s_and_b32 s17, s49, 0xffff
    s_mov_b32 s18, 31473664
    s_mov_b32 s19, 0x00020000
    s_mov_b32 s20, s50
    s_and_b32 s21, s51, 0xffff
    s_mov_b32 s22, 15736832
    s_mov_b32 s23, 0x00020000
    s_mov_b32 s24, s52
    s_and_b32 s25, s53, 0xffff
    s_mov_b32 s26, 15736832
    s_mov_b32 s27, 0x00020000
    s_mov_b32 s28, s56
    s_and_b32 s29, s57, 0xffff
    s_mov_b32 s30, 31473664
    s_mov_b32 s31, 0x00020000
    v_and_b32 v1, 63, v0
    s_waitcnt lgkmcnt(0)
    s_sub_u32 s32, s5, s4
    s_add_u32 s32, s32, 63
    s_lshr_b32 s32, s32, 6
    s_sub_u32 s33, s6, s5
    s_add_u32 s33, s33, 63
    s_lshr_b32 s33, s33, 6
    s_sub_u32 s34, s7, s6
    s_add_u32 s34, s34, 63
    s_lshr_b32 s34, s34, 6
    s_sub_u32 s35, s8, s7
    s_add_u32 s35, s35, 63
    s_lshr_b32 s35, s35, 6
    s_sub_u32 s36, s9, s8
    s_add_u32 s36, s36, 63
    s_lshr_b32 s36, s36, 6
    s_sub_u32 s37, s10, s9
    s_add_u32 s37, s37, 63
    s_lshr_b32 s37, s37, 6
    s_sub_u32 s38, s11, s10
    s_add_u32 s38, s38, 63
    s_lshr_b32 s38, s38, 6
    s_sub_u32 s39, s12, s11
    s_add_u32 s39, s39, 63
    s_lshr_b32 s39, s39, 6
    v_mov_b32 v5, 0
    v_add_u32 v7, 64, v1
    v_mov_b32 v8, 0
    v_sub_u32 v6, s32, v1
    v_max_i32 v6, 0, v6
    v_add_u32 v5, v5, v6
    v_sub_u32 v6, s32, v7
    v_max_i32 v6, 0, v6
    v_add_u32 v8, v8, v6
    v_sub_u32 v6, s33, v1
    v_max_i32 v6, 0, v6
    v_add_u32 v5, v5, v6
    v_sub_u32 v6, s33, v7
    v_max_i32 v6, 0, v6
    v_add_u32 v8, v8, v6
    v_sub_u32 v6, s34, v1
    v_max_i32 v6, 0, v6
    v_add_u32 v5, v5, v6
    v_sub_u32 v6, s34, v7
    v_max_i32 v6, 0, v6
    v_add_u32 v8, v8, v6
    v_sub_u32 v6, s35, v1
    v_max_i32 v6, 0, v6
    v_add_u32 v5, v5, v6
    v_sub_u32 v6, s35, v7
    v_max_i32 v6, 0, v6
    v_add_u32 v8, v8, v6
    v_sub_u32 v6, s36, v1
    v_max_i32 v6, 0, v6
    v_add_u32 v5, v5, v6
    v_sub_u32 v6, s36, v7
    v_max_i32 v6, 0, v6
    v_add_u32 v8, v8, v6
    v_sub_u32 v6, s37, v1
    v_max_i32 v6, 0, v6
    v_add_u32 v5, v5, v6
    v_sub_u32 v6, s37, v7
    v_max_i32 v6, 0, v6
    v_add_u32 v8, v8, v6
    v_sub_u32 v6, s38, v1
    v_max_i32 v6, 0, v6
    v_add_u32 v5, v5, v6
    v_sub_u32 v6, s38, v7
    v_max_i32 v6, 0, v6
    v_add_u32 v8, v8, v6
    v_sub_u32 v6, s39, v1
    v_max_i32 v6, 0, v6
    v_add_u32 v5, v5, v6
    v_sub_u32 v6, s39, v7
    v_max_i32 v6, 0, v6
    v_add_u32 v8, v8, v6
    v_cmp_lt_u32 vcc, s40, v5
    s_nop 3
    s_bcnt1_i32_b64 s45, vcc
    v_cmp_lt_u32 vcc, s40, v8
    s_nop 3
    s_bcnt1_i32_b64 s46, vcc
    s_add_u32 s45, s45, s46
    s_cmp_eq_u32 s45, 0
    s_cbranch_scc1 L_end
    s_sub_u32 s42, s45, 1
    s_mov_b32 s3, s45
    s_mov_b32 s45, 0
    s_sub_u32 s46, s32, s3
    s_max_i32 s46, s46, 0
    s_add_u32 s45, s45, s46
    s_sub_u32 s46, s33, s3
    s_max_i32 s46, s46, 0
    s_add_u32 s45, s45, s46
    s_sub_u32 s46, s34, s3
    s_max_i32 s46, s46, 0
    s_add_u32 s45, s45, s46
    s_sub_u32 s46, s35, s3
    s_max_i32 s46, s46, 0
    s_add_u32 s45, s45, s46
    s_sub_u32 s46, s36, s3
    s_max_i32 s46, s46, 0
    s_add_u32 s45, s45, s46
    s_sub_u32 s46, s37, s3
    s_max_i32 s46, s46, 0
    s_add_u32 s45, s45, s46
    s_sub_u32 s46, s38, s3
    s_max_i32 s46, s46, 0
    s_add_u32 s45, s45, s46
    s_sub_u32 s46, s39, s3
    s_max_i32 s46, s46, 0
    s_add_u32 s45, s45, s46
    s_sub_u32 s45, s40, s45
    s_mov_b32 s43, 0
    s_mov_b32 s44, 0
    s_cmp_gt_i32 s32, s42
    s_cselect_b32 s46, s45, -1
    s_cmp_eq_u32 s46, 0
    s_cselect_b32 s43, s4, s43
    s_cselect_b32 s44, s5, s44
    s_cmp_gt_i32 s32, s42
    s_subb_u32 s45, s45, 0
    s_cmp_gt_i32 s33, s42
    s_cselect_b32 s46, s45, -1
    s_cmp_eq_u32 s46, 0
    s_cselect_b32 s43, s5, s43
    s_cselect_b32 s44, s6, s44
    s_cmp_gt_i32 s33, s42
    s_subb_u32 s45, s45, 0
    s_cmp_gt_i32 s34, s42
    s_cselect_b32 s46, s45, -1
    s_cmp_eq_u32 s46, 0
    s_cselect_b32 s43, s6, s43
    s_cselect_b32 s44, s7, s44
    s_cmp_gt_i32 s34, s42
    s_subb_u32 s45, s45, 0
    s_cmp_gt_i32 s35, s42
    s_cselect_b32 s46, s45, -1
    s_cmp_eq_u32 s46, 0
    s_cselect_b32 s43, s7, s43
    s_cselect_b32 s44, s8, s44
    s_cmp_gt_i32 s35, s42
    s_subb_u32 s45, s45, 0
    s_cmp_gt_i32 s36, s42
    s_cselect_b32 s46, s45, -1
    s_cmp_eq_u32 s46, 0
    s_cselect_b32 s43, s8, s43
    s_cselect_b32 s44, s9, s44
    s_cmp_gt_i32 s36, s42
    s_subb_u32 s45, s45, 0
    s_cmp_gt_i32 s37, s42
    s_cselect_b32 s46, s45, -1
    s_cmp_eq_u32 s46, 0
    s_cselect_b32 s43, s9, s43
    s_cselect_b32 s44, s10, s44
    s_cmp_gt_i32 s37, s42
    s_subb_u32 s45, s45, 0
    s_cmp_gt_i32 s38, s42
    s_cselect_b32 s46, s45, -1
    s_cmp_eq_u32 s46, 0
    s_cselect_b32 s43, s10, s43
    s_cselect_b32 s44, s11, s44
    s_cmp_gt_i32 s38, s42
    s_subb_u32 s45, s45, 0
    s_cmp_gt_i32 s39, s42
    s_cselect_b32 s46, s45, -1
    s_cmp_eq_u32 s46, 0
    s_cselect_b32 s43, s11, s43
    s_cselect_b32 s44, s12, s44
    s_cmp_gt_i32 s39, s42
    s_subb_u32 s45, s45, 0
    s_sub_u32 s44, s44, s43
    s_add_u32 s58, s42, 1
    s_mov_b32 s59, s42
    s_mov_b32 s60, 0
    s_mov_b32 s63, 0
    s_mov_b32 s64, 0x3e0293ee
    v_readfirstlane_b32 s47, v0
    s_nop 3
    s_lshr_b32 s47, s47, 6
    s_lshl_b32 s65, s47, 12
    s_lshl_b32 s69, s47, 4
    s_and_b32 s3, s47, 1
    s_lshl_b32 s66, s41, 1
    s_add_u32 s66, s66, s3
    s_lshr_b32 s3, s47, 1
    s_lshl_b32 s3, s3, 5
    s_lshl_b32 s46, s42, 6
    s_add_u32 s46, s46, s3
    s_sub_u32 s78, s44, s46
    s_add_u32 s67, s43, s46
    s_lshl_b32 s68, s67, 12
    s_lshl_b32 s45, s66, 8
    s_add_u32 s68, s68, s45
    s_lshl_b32 s61, s43, 11
    s_lshl_b32 s45, s41, 8
    s_add_u32 s61, s61, s45
    v_and_b32 v241, 31, v1
    v_lshrrev_b32 v242, 5, v1
    v_and_b32 v243, 15, v1
    v_lshrrev_b32 v244, 4, v1
    v_lshlrev_b32 v245, 12, v241
    v_lshl_add_u32 v245, v242, 4, v245
    v_add_u32 v11, s68, v245
    buffer_load_dwordx4 v[192:195], v11, s[16:19], 0 offen offset:0
    buffer_load_dwordx4 v[196:199], v11, s[16:19], 0 offen offset:32
    buffer_load_dwordx4 v[200:203], v11, s[16:19], 0 offen offset:64
    buffer_load_dwordx4 v[204:207], v11, s[16:19], 0 offen offset:96
    buffer_load_dwordx4 v[208:211], v11, s[16:19], 0 offen offset:128
    buffer_load_dwordx4 v[212:215], v11, s[16:19], 0 offen offset:160
    buffer_load_dwordx4 v[216:219], v11, s[16:19], 0 offen offset:192
    buffer_load_dwordx4 v[220:223], v11, s[16:19], 0 offen offset:224
    v_add_u32 v245, s69, v244
    v_lshlrev_b32 v245, 11, v245
    v_lshl_or_b32 v246, v244, 2, 0
    v_xor_b32 v246, v246, v243
    v_lshl_add_u32 v12, v246, 4, v245
    v_lshl_or_b32 v246, v244, 2, 1
    v_xor_b32 v246, v246, v243
    v_lshl_add_u32 v13, v246, 4, v245
    v_add_u32 v13, 7168, v13
    v_lshl_or_b32 v246, v244, 2, 2
    v_xor_b32 v246, v246, v243
    v_lshl_add_u32 v14, v246, 4, v245
    v_add_u32 v14, 14336, v14
    v_lshl_or_b32 v246, v244, 2, 3
    v_xor_b32 v246, v246, v243
    v_lshl_add_u32 v15, v246, 4, v245
    v_add_u32 v15, 21504, v15
    v_and_b32 v246, 3, v241
    v_lshlrev_b32 v246, 2, v246
    v_bfe_u32 v247, v241, 2, 2
    v_or_b32 v246, v246, v247
    v_xor_b32 v246, v246, v242
    v_lshlrev_b32 v246, 4, v246
    v_lshlrev_b32 v247, 8, v241
    v_xor_b32 v248, 0, v246
    v_add_u32 v16, v248, v247
    v_xor_b32 v248, 32, v246
    v_add_u32 v17, v248, v247
    v_xor_b32 v248, 64, v246
    v_add_u32 v18, v248, v247
    v_xor_b32 v248, 96, v246
    v_add_u32 v19, v248, v247
    v_xor_b32 v248, 128, v246
    v_add_u32 v20, v248, v247
    v_xor_b32 v248, 160, v246
    v_add_u32 v21, v248, v247
    v_xor_b32 v248, 192, v246
    v_add_u32 v22, v248, v247
    v_xor_b32 v248, 224, v246
    v_add_u32 v23, v248, v247
    v_and_b32 v246, 1, v244
    v_lshlrev_b32 v246, 1, v246
    v_bfe_u32 v247, v243, 1, 1
    v_or_b32 v246, v246, v247
    v_lshrrev_b32 v247, 2, v243
    v_lshl_or_b32 v246, v247, 2, v246
    v_xor_b32 v246, v246, v242
    v_lshlrev_b32 v246, 4, v246
    v_lshl_add_u32 v247, v242, 2, v247
    v_lshlrev_b32 v247, 8, v247
    v_and_b32 v248, 1, v243
    v_lshl_add_u32 v247, v248, 3, v247
    v_xor_b32 v248, 0, v246
    v_add_u32 v24, v248, v247
    v_xor_b32 v248, 32, v246
    v_add_u32 v25, v248, v247
    v_xor_b32 v248, 64, v246
    v_add_u32 v26, v248, v247
    v_xor_b32 v248, 96, v246
    v_add_u32 v27, v248, v247
    v_xor_b32 v248, 128, v246
    v_add_u32 v28, v248, v247
    v_xor_b32 v248, 160, v246
    v_add_u32 v29, v248, v247
    v_xor_b32 v248, 192, v246
    v_add_u32 v30, v248, v247
    v_xor_b32 v248, 224, v246
    v_add_u32 v31, v248, v247
    s_lshr_b32 s3, s47, 1
    s_lshl_b32 s3, s3, 5
    v_lshlrev_b32 v246, 2, v242
    v_sub_u32 v246, v241, v246
    v_add_u32 v240, s3, v246
    s_add_u32 s62, s61, 131072
    s_add_u32 m0, s65, 0
    s_nop 0
    buffer_load_dwordx4 v12, s[20:23], s61 offen offset:0 lds
    buffer_load_dwordx4 v13, s[20:23], s61 offen offset:1024 lds
    buffer_load_dwordx4 v14, s[20:23], s61 offen offset:2048 lds
    buffer_load_dwordx4 v15, s[20:23], s61 offen offset:3072 lds
    s_add_u32 m0, s65, 16384
    s_nop 0
    buffer_load_dwordx4 v12, s[20:23], s62 offen offset:0 lds
    buffer_load_dwordx4 v13, s[20:23], s62 offen offset:1024 lds
    buffer_load_dwordx4 v14, s[20:23], s62 offen offset:2048 lds
    buffer_load_dwordx4 v15, s[20:23], s62 offen offset:3072 lds
    v_mov_b32 v3, 0
    v_mov_b32 v2, 0xf149f2ca
    v_mov_b32 v4, 1.0
    v_mov_b32 v64, 0
    v_mov_b32 v65, 0
    v_mov_b32 v66, 0
    v_mov_b32 v67, 0
    v_mov_b32 v68, 0
    v_mov_b32 v69, 0
    v_mov_b32 v70, 0
    v_mov_b32 v71, 0
    v_mov_b32 v72, 0
    v_mov_b32 v73, 0
    v_mov_b32 v74, 0
    v_mov_b32 v75, 0
    v_mov_b32 v76, 0
    v_mov_b32 v77, 0
    v_mov_b32 v78, 0
    v_mov_b32 v79, 0
    v_mov_b32 v80, 0
    v_mov_b32 v81, 0
    v_mov_b32 v82, 0
    v_mov_b32 v83, 0
    v_mov_b32 v84, 0
    v_mov_b32 v85, 0
    v_mov_b32 v86, 0
    v_mov_b32 v87, 0
    v_mov_b32 v88, 0
    v_mov_b32 v89, 0
    v_mov_b32 v90, 0
    v_mov_b32 v91, 0
    v_mov_b32 v92, 0
    v_mov_b32 v93, 0
    v_mov_b32 v94, 0
    v_mov_b32 v95, 0
    v_mov_b32 v96, 0
    v_mov_b32 v97, 0
    v_mov_b32 v98, 0
    v_mov_b32 v99, 0
    v_mov_b32 v100, 0
    v_mov_b32 v101, 0
    v_mov_b32 v102, 0
    v_mov_b32 v103, 0
    v_mov_b32 v104, 0
    v_mov_b32 v105, 0
    v_mov_b32 v106, 0
    v_mov_b32 v107, 0
    v_mov_b32 v108, 0
    v_mov_b32 v109, 0
    v_mov_b32 v110, 0
    v_mov_b32 v111, 0
    v_mov_b32 v112, 0
    v_mov_b32 v113, 0
    v_mov_b32 v114, 0
    v_mov_b32 v115, 0
    v_mov_b32 v116, 0
    v_mov_b32 v117, 0
    v_mov_b32 v118, 0
    v_mov_b32 v119, 0
    v_mov_b32 v120, 0
    v_mov_b32 v121, 0
    v_mov_b32 v122, 0
    v_mov_b32 v123, 0
    v_mov_b32 v124, 0
    v_mov_b32 v125, 0
    v_mov_b32 v126, 0
    v_mov_b32 v127, 0
    s_waitcnt vmcnt(4)
    s_barrier
    ds_read_b128 v[32:35], v16 offset:0
    ds_read_b128 v[36:39], v17 offset:0
    ds_read_b128 v[40:43], v18 offset:0
    ds_read_b128 v[44:47], v19 offset:0
    s_waitcnt lgkmcnt(3)
    v_mfma_f32_32x32x16_bf16 v[128:143], v[32:35], v[192:195], 0
    ds_read_b128 v[48:51], v20 offset:0
    s_waitcnt lgkmcnt(3)
    v_mfma_f32_32x32x16_bf16 v[128:143], v[36:39], v[196:199], v[128:143]
    ds_read_b128 v[52:55], v21 offset:0
    s_waitcnt lgkmcnt(3)
    v_mfma_f32_32x32x16_bf16 v[128:143], v[40:43], v[200:203], v[128:143]
    ds_read_b128 v[56:59], v22 offset:0
    s_waitcnt lgkmcnt(3)
    v_mfma_f32_32x32x16_bf16 v[128:143], v[44:47], v[204:207], v[128:143]
    ds_read_b128 v[60:63], v23 offset:0
    s_waitcnt lgkmcnt(3)
    v_mfma_f32_32x32x16_bf16 v[128:143], v[48:51], v[208:211], v[128:143]
    ds_read_b128 v[32:35], v16 offset:8192
    s_waitcnt lgkmcnt(3)
    v_mfma_f32_32x32x16_bf16 v[128:143], v[52:55], v[212:215], v[128:143]
    ds_read_b128 v[36:39], v17 offset:8192
    s_waitcnt lgkmcnt(3)
    v_mfma_f32_32x32x16_bf16 v[128:143], v[56:59], v[216:219], v[128:143]
    ds_read_b128 v[40:43], v18 offset:8192
    s_waitcnt lgkmcnt(3)
    v_mfma_f32_32x32x16_bf16 v[128:143], v[60:63], v[220:223], v[128:143]
    ds_read_b128 v[44:47], v19 offset:8192
    s_waitcnt lgkmcnt(3)
    v_mfma_f32_32x32x16_bf16 v[144:159], v[32:35], v[192:195], 0
    ds_read_b128 v[48:51], v20 offset:8192
    s_waitcnt lgkmcnt(3)
    v_mfma_f32_32x32x16_bf16 v[144:159], v[36:39], v[196:199], v[144:159]
    ds_read_b128 v[52:55], v21 offset:8192
    s_waitcnt lgkmcnt(3)
    v_mfma_f32_32x32x16_bf16 v[144:159], v[40:43], v[200:203], v[144:159]
    ds_read_b128 v[56:59], v22 offset:8192
    s_waitcnt lgkmcnt(3)
    v_mfma_f32_32x32x16_bf16 v[144:159], v[44:47], v[204:207], v[144:159]
    ds_read_b128 v[60:63], v23 offset:8192
    s_waitcnt lgkmcnt(3)
    v_mfma_f32_32x32x16_bf16 v[144:159], v[48:51], v[208:211], v[144:159]
    s_waitcnt lgkmcnt(2)
    v_mfma_f32_32x32x16_bf16 v[144:159], v[52:55], v[212:215], v[144:159]
    s_waitcnt lgkmcnt(1)
    v_mfma_f32_32x32x16_bf16 v[144:159], v[56:59], v[216:219], v[144:159]
    s_waitcnt lgkmcnt(0)
    v_mfma_f32_32x32x16_bf16 v[144:159], v[60:63], v[220:223], v[144:159]
    s_cmp_eq_u32 s59, 0
    s_cbranch_scc1 L_S0
    s_waitcnt vmcnt(0)
    s_barrier
    ds_read_b128 v[32:35], v16 offset:16384
    ds_read_b128 v[36:39], v17 offset:16384
    ds_read_b128 v[40:43], v18 offset:16384
    ds_read_b128 v[44:47], v19 offset:16384
    s_add_u32 s3, s60, 2
    s_cmp_lt_u32 s3, s58
    s_cbranch_scc0 L_nok_F0
    s_add_u32 s62, s61, 262144
    s_add_u32 m0, s65, 0
    s_nop 0
    buffer_load_dwordx4 v12, s[20:23], s62 offen offset:0 lds
    buffer_load_dwordx4 v13, s[20:23], s62 offen offset:1024 lds
    buffer_load_dwordx4 v14, s[20:23], s62 offen offset:2048 lds
    buffer_load_dwordx4 v15, s[20:23], s62 offen offset:3072 lds
L_nok_F0:
    s_add_u32 m0, s65, 32768
    s_nop 0
    buffer_load_dwordx4 v12, s[24:27], s61 offen offset:0 lds
    buffer_load_dwordx4 v13, s[24:27], s61 offen offset:1024 lds
    buffer_load_dwordx4 v14, s[24:27], s61 offen offset:2048 lds
    buffer_load_dwordx4 v15, s[24:27], s61 offen offset:3072 lds
    s_add_u32 s61, s61, 131072
    v_max3_f32 v5, v128, v129, v130
    v_max3_f32 v6, v131, v132, v133
    v_max3_f32 v7, v134, v135, v136
    v_max3_f32 v8, v137, v138, v139
    v_max3_f32 v5, v5, v140, v141
    v_max3_f32 v6, v6, v142, v143
    v_max3_f32 v7, v7, v144, v145
    v_max3_f32 v8, v8, v146, v147
    v_max3_f32 v5, v5, v148, v149
    v_max3_f32 v6, v6, v150, v151
    s_waitcnt lgkmcnt(3)
    v_mfma_f32_32x32x16_bf16 v[160:175], v[32:35], v[192:195], 0
    ds_read_b128 v[48:51], v20 offset:16384
    v_max3_f32 v7, v7, v152, v153
    v_max3_f32 v8, v8, v154, v155
    v_max3_f32 v5, v5, v156, v157
    v_max3_f32 v6, v6, v158, v159
    v_max3_f32 v5, v5, v6, v7
    v_max_f32 v5, v5, v8
    v_mov_b32 v6, v5
    s_nop 1
    v_permlane32_swap_b32 v5, v6
    v_max_f32 v5, v5, v6
    v_mul_f32 v5, s64, v5
    v_mov_b32 v2, v5
    s_waitcnt lgkmcnt(3)
    v_mfma_f32_32x32x16_bf16 v[160:175], v[36:39], v[196:199], v[160:175]
    ds_read_b128 v[52:55], v21 offset:16384
    v_fma_f32 v128, v128, s64, -v2
    v_fma_f32 v129, v129, s64, -v2
    v_fma_f32 v130, v130, s64, -v2
    v_fma_f32 v131, v131, s64, -v2
    v_exp_f32 v128, v128
    v_exp_f32 v129, v129
    s_waitcnt lgkmcnt(3)
    v_mfma_f32_32x32x16_bf16 v[160:175], v[40:43], v[200:203], v[160:175]
    ds_read_b128 v[56:59], v22 offset:16384
    v_exp_f32 v130, v130
    v_exp_f32 v131, v131
    v_fma_f32 v132, v132, s64, -v2
    v_fma_f32 v133, v133, s64, -v2
    v_fma_f32 v134, v134, s64, -v2
    v_fma_f32 v135, v135, s64, -v2
    v_exp_f32 v132, v132
    s_waitcnt lgkmcnt(3)
    v_mfma_f32_32x32x16_bf16 v[160:175], v[44:47], v[204:207], v[160:175]
    ds_read_b128 v[60:63], v23 offset:16384
    v_exp_f32 v133, v133
    v_exp_f32 v134, v134
    v_exp_f32 v135, v135
    v_add_f32 v9, v128, v129
    v_add_f32 v10, v130, v131
    v_fma_f32 v136, v136, s64, -v2
    v_fma_f32 v137, v137, s64, -v2
    s_waitcnt lgkmcnt(3)
    v_mfma_f32_32x32x16_bf16 v[160:175], v[48:51], v[208:211], v[160:175]
    ds_read_b128 v[32:35], v16 offset:24576
    v_fma_f32 v138, v138, s64, -v2
    v_fma_f32 v139, v139, s64, -v2
    v_exp_f32 v136, v136
    v_exp_f32 v137, v137
    v_exp_f32 v138, v138
    v_exp_f32 v139, v139
    s_waitcnt lgkmcnt(3)
    v_mfma_f32_32x32x16_bf16 v[160:175], v[52:55], v[212:215], v[160:175]
    ds_read_b128 v[36:39], v17 offset:24576
    v_add_f32 v9, v9, v132
    v_add_f32 v10, v10, v133
    v_add_f32 v9, v9, v134
    v_add_f32 v10, v10, v135
    v_fma_f32 v140, v140, s64, -v2
    v_fma_f32 v141, v141, s64, -v2
    v_fma_f32 v142, v142, s64, -v2
    v_fma_f32 v143, v143, s64, -v2
    v_exp_f32 v140, v140
    s_waitcnt lgkmcnt(3)
    v_mfma_f32_32x32x16_bf16 v[160:175], v[56:59], v[216:219], v[160:175]
    ds_read_b128 v[40:43], v18 offset:24576
    v_exp_f32 v141, v141
    v_exp_f32 v142, v142
    v_exp_f32 v143, v143
    v_add_f32 v9, v9, v136
    v_add_f32 v10, v10, v137
    v_add_f32 v9, v9, v138
    s_waitcnt lgkmcnt(3)
    v_mfma_f32_32x32x16_bf16 v[160:175], v[60:63], v[220:223], v[160:175]
    ds_read_b128 v[44:47], v19 offset:24576
    v_add_f32 v10, v10, v139
    v_fma_f32 v144, v144, s64, -v2
    v_fma_f32 v145, v145, s64, -v2
    v_fma_f32 v146, v146, s64, -v2
    v_fma_f32 v147, v147, s64, -v2
    v_exp_f32 v144, v144
    v_exp_f32 v145, v145
    v_exp_f32 v146, v146
    s_waitcnt lgkmcnt(3)
    v_mfma_f32_32x32x16_bf16 v[176:191], v[32:35], v[192:195], 0
    ds_read_b128 v[48:51], v20 offset:24576
    v_exp_f32 v147, v147
    v_add_f32 v9, v9, v140
    v_add_f32 v10, v10, v141
    v_add_f32 v9, v9, v142
    v_add_f32 v10, v10, v143
    v_fma_f32 v148, v148, s64, -v2
    v_fma_f32 v149, v149, s64, -v2
    v_fma_f32 v150, v150, s64, -v2
    s_waitcnt lgkmcnt(3)
    v_mfma_f32_32x32x16_bf16 v[176:191], v[36:39], v[196:199], v[176:191]
    ds_read_b128 v[52:55], v21 offset:24576
    v_fma_f32 v151, v151, s64, -v2
    v_exp_f32 v148, v148
    v_exp_f32 v149, v149
    v_exp_f32 v150, v150
    v_exp_f32 v151, v151
    v_add_f32 v9, v9, v144
    s_waitcnt lgkmcnt(3)
    v_mfma_f32_32x32x16_bf16 v[176:191], v[40:43], v[200:203], v[176:191]
    ds_read_b128 v[56:59], v22 offset:24576
    v_add_f32 v10, v10, v145
    v_add_f32 v9, v9, v146
    v_add_f32 v10, v10, v147
    v_fma_f32 v152, v152, s64, -v2
    v_fma_f32 v153, v153, s64, -v2
    v_fma_f32 v154, v154, s64, -v2
    v_fma_f32 v155, v155, s64, -v2
    v_exp_f32 v152, v152
    s_waitcnt lgkmcnt(3)
    v_mfma_f32_32x32x16_bf16 v[176:191], v[44:47], v[204:207], v[176:191]
    ds_read_b128 v[60:63], v23 offset:24576
    v_exp_f32 v153, v153
    v_exp_f32 v154, v154
    v_exp_f32 v155, v155
    v_add_f32 v9, v9, v148
    v_add_f32 v10, v10, v149
    v_add_f32 v9, v9, v150
    v_add_f32 v10, v10, v151
    s_waitcnt lgkmcnt(3)
    v_mfma_f32_32x32x16_bf16 v[176:191], v[48:51], v[208:211], v[176:191]
    v_fma_f32 v156, v156, s64, -v2
    v_fma_f32 v157, v157, s64, -v2
    v_fma_f32 v158, v158, s64, -v2
    v_fma_f32 v159, v159, s64, -v2
    v_exp_f32 v156, v156
    v_exp_f32 v157, v157
    v_exp_f32 v158, v158
    s_waitcnt lgkmcnt(2)
    v_mfma_f32_32x32x16_bf16 v[176:191], v[52:55], v[212:215], v[176:191]
    v_exp_f32 v159, v159
    v_add_f32 v9, v9, v152
    v_add_f32 v10, v10, v153
    v_add_f32 v9, v9, v154
    v_add_f32 v10, v10, v155
    v_mov_b32 v6, v6
    v_add_f32 v9, v9, v156
    v_add_f32 v10, v10, v157
    v_add_f32 v9, v9, v158
    s_waitcnt lgkmcnt(1)
    v_mfma_f32_32x32x16_bf16 v[176:191], v[56:59], v[216:219], v[176:191]
    v_add_f32 v10, v10, v159
    v_add_f32 v9, v9, v10
    v_add_f32 v3, v3, v9
    v_cvt_pk_bf16_f32 v224, v128, v129
    v_cvt_pk_bf16_f32 v225, v130, v131
    v_cvt_pk_bf16_f32 v226, v132, v133
    v_cvt_pk_bf16_f32 v227, v134, v135
    v_cvt_pk_bf16_f32 v228, v136, v137
    v_cvt_pk_bf16_f32 v229, v138, v139
    v_cvt_pk_bf16_f32 v230, v140, v141
    s_waitcnt lgkmcnt(0)
    v_mfma_f32_32x32x16_bf16 v[176:191], v[60:63], v[220:223], v[176:191]
    v_cvt_pk_bf16_f32 v231, v142, v143
    v_cvt_pk_bf16_f32 v232, v144, v145
    v_cvt_pk_bf16_f32 v233, v146, v147
    v_cvt_pk_bf16_f32 v234, v148, v149
    v_cvt_pk_bf16_f32 v235, v150, v151
    v_cvt_pk_bf16_f32 v236, v152, v153
    v_cvt_pk_bf16_f32 v237, v154, v155
    v_cvt_pk_bf16_f32 v238, v156, v157
    v_cvt_pk_bf16_f32 v239, v158, v159
    s_mov_b32 s60, 1
L_odd:
    s_cmp_eq_u32 s60, s59
    s_cbranch_scc1 L_L1
    s_waitcnt vmcnt(0)
    s_barrier
    ds_read_b64_tr_b16 v[32:33], v24 offset:32768
    ds_read_b64_tr_b16 v[34:35], v25 offset:34816
    ds_read_b64_tr_b16 v[36:37], v26 offset:32768
    ds_read_b64_tr_b16 v[38:39], v27 offset:34816
    ds_read_b64_tr_b16 v[40:41], v28 offset:32768
    ds_read_b64_tr_b16 v[42:43], v29 offset:34816
    ds_read_b64_tr_b16 v[44:45], v30 offset:32768
    ds_read_b64_tr_b16 v[46:47], v31 offset:34816
    s_cmp_eq_u32 s63, 0
    s_cbranch_scc1 L_noo_M1
    v_mul_f32 v64, v64, v4
    v_mul_f32 v65, v65, v4
    v_mul_f32 v66, v66, v4
    v_mul_f32 v67, v67, v4
    v_mul_f32 v68, v68, v4
    v_mul_f32 v69, v69, v4
    v_mul_f32 v70, v70, v4
    v_mul_f32 v71, v71, v4
    v_mul_f32 v72, v72, v4
    v_mul_f32 v73, v73, v4
    v_mul_f32 v74, v74, v4
    v_mul_f32 v75, v75, v4
    v_mul_f32 v76, v76, v4
    v_mul_f32 v77, v77, v4
    v_mul_f32 v78, v78, v4
    v_mul_f32 v79, v79, v4
    v_mul_f32 v80, v80, v4
    v_mul_f32 v81, v81, v4
    v_mul_f32 v82, v82, v4
    v_mul_f32 v83, v83, v4
    v_mul_f32 v84, v84, v4
    v_mul_f32 v85, v85, v4
    v_mul_f32 v86, v86, v4
    v_mul_f32 v87, v87, v4
    v_mul_f32 v88, v88, v4
    v_mul_f32 v89, v89, v4
    v_mul_f32 v90, v90, v4
    v_mul_f32 v91, v91, v4
    v_mul_f32 v92, v92, v4
    v_mul_f32 v93, v93, v4
    v_mul_f32 v94, v94, v4
    v_mul_f32 v95, v95, v4
    v_mul_f32 v96, v96, v4
    v_mul_f32 v97, v97, v4
    v_mul_f32 v98, v98, v4
    v_mul_f32 v99, v99, v4
    v_mul_f32 v100, v100, v4
    v_mul_f32 v101, v101, v4
    v_mul_f32 v102, v102, v4
    v_mul_f32 v103, v103, v4
    v_mul_f32 v104, v104, v4
    v_mul_f32 v105, v105, v4
    v_mul_f32 v106, v106, v4
    v_mul_f32 v107, v107, v4
    v_mul_f32 v108, v108, v4
    v_mul_f32 v109, v109, v4
    v_mul_f32 v110, v110, v4
    v_mul_f32 v111, v111, v4
    v_mul_f32 v112, v112, v4
    v_mul_f32 v113, v113, v4
    v_mul_f32 v114, v114, v4
    v_mul_f32 v115, v115, v4
    v_mul_f32 v116, v116, v4
    v_mul_f32 v117, v117, v4
    v_mul_f32 v118, v118, v4
    v_mul_f32 v119, v119, v4
    v_mul_f32 v120, v120, v4
    v_mul_f32 v121, v121, v4
    v_mul_f32 v122, v122, v4
    v_mul_f32 v123, v123, v4
    v_mul_f32 v124, v124, v4
    v_mul_f32 v125, v125, v4
    v_mul_f32 v126, v126, v4
    v_mul_f32 v127, v127, v4
    s_mov_b32 s63, 0
    s_nop 1
L_noo_M1:
    s_add_u32 s3, s60, 2
    s_cmp_lt_u32 s3, s58
    s_cbranch_scc0 L_nok_M1
    s_add_u32 s62, s61, 262144
    s_add_u32 m0, s65, 16384
    s_nop 0
    buffer_load_dwordx4 v12, s[20:23], s62 offen offset:0 lds
    buffer_load_dwordx4 v13, s[20:23], s62 offen offset:1024 lds
    buffer_load_dwordx4 v14, s[20:23], s62 offen offset:2048 lds
    buffer_load_dwordx4 v15, s[20:23], s62 offen offset:3072 lds
L_nok_M1:
    s_add_u32 m0, s65, 49152
    s_nop 0
    buffer_load_dwordx4 v12, s[24:27], s61 offen offset:0 lds
    buffer_load_dwordx4 v13, s[24:27], s61 offen offset:1024 lds
    buffer_load_dwordx4 v14, s[24:27], s61 offen offset:2048 lds
    buffer_load_dwordx4 v15, s[24:27], s61 offen offset:3072 lds
    s_add_u32 s61, s61, 131072
    v_max3_f32 v5, v160, v161, v162
    v_max3_f32 v6, v163, v164, v165
    v_max3_f32 v7, v166, v167, v168
    v_max3_f32 v8, v169, v170, v171
    v_max3_f32 v5, v5, v172, v173
    v_max3_f32 v6, v6, v174, v175
    v_max3_f32 v7, v7, v176, v177
    v_max3_f32 v8, v8, v178, v179
    s_waitcnt lgkmcnt(6)
    v_mfma_f32_32x32x16_bf16 v[64:79], v[32:35], v[224:227], v[64:79]
    ds_read_b64_tr_b16 v[48:49], v24 offset:36864
    ds_read_b64_tr_b16 v[50:51], v25 offset:38912
    v_max3_f32 v5, v5, v180, v181
    v_max3_f32 v6, v6, v182, v183
    v_max3_f32 v7, v7, v184, v185
    v_max3_f32 v8, v8, v186, v187
    v_max3_f32 v5, v5, v188, v189
    v_max3_f32 v6, v6, v190, v191
    s_waitcnt lgkmcnt(6)
    v_mfma_f32_32x32x16_bf16 v[80:95], v[36:39], v[224:227], v[80:95]
    ds_read_b64_tr_b16 v[52:53], v26 offset:36864
    ds_read_b64_tr_b16 v[54:55], v27 offset:38912
    v_max3_f32 v5, v5, v6, v7
    v_max_f32 v5, v5, v8
    v_mov_b32 v6, v5
    s_nop 1
    v_permlane32_swap_b32 v5, v6
    v_max_f32 v5, v5, v6
    v_mul_f32 v5, s64, v5
    v_sub_f32 v6, v5, v2
    v_cmp_lt_f32 vcc, 0x41000000, v6
    s_cbranch_vccz L_nors_M1
    v_max_f32 v7, v2, v5
    v_sub_f32 v8, v2, v7
    v_exp_f32 v4, v8
    v_mov_b32 v2, v7
    s_mov_b32 s63, 1
    v_mul_f32 v3, v3, v4
L_nors_M1:
    s_waitcnt lgkmcnt(6)
    v_mfma_f32_32x32x16_bf16 v[96:111], v[40:43], v[224:227], v[96:111]
    ds_read_b64_tr_b16 v[56:57], v28 offset:36864
    ds_read_b64_tr_b16 v[58:59], v29 offset:38912
    s_waitcnt lgkmcnt(6)
    v_mfma_f32_32x32x16_bf16 v[112:127], v[44:47], v[224:227], v[112:127]
    ds_read_b64_tr_b16 v[60:61], v30 offset:36864
    ds_read_b64_tr_b16 v[62:63], v31 offset:38912
    s_waitcnt lgkmcnt(6)
    v_mfma_f32_32x32x16_bf16 v[64:79], v[48:51], v[228:231], v[64:79]
    ds_read_b64_tr_b16 v[32:33], v24 offset:40960
    ds_read_b64_tr_b16 v[34:35], v25 offset:43008
    v_fma_f32 v160, v160, s64, -v2
    v_fma_f32 v161, v161, s64, -v2
    v_fma_f32 v162, v162, s64, -v2
    v_fma_f32 v163, v163, s64, -v2
    s_waitcnt lgkmcnt(6)
    v_mfma_f32_32x32x16_bf16 v[80:95], v[52:55], v[228:231], v[80:95]
    ds_read_b64_tr_b16 v[36:37], v26 offset:40960
    ds_read_b64_tr_b16 v[38:39], v27 offset:43008
    v_exp_f32 v160, v160
    v_exp_f32 v161, v161
    v_exp_f32 v162, v162
    s_waitcnt lgkmcnt(6)
    v_mfma_f32_32x32x16_bf16 v[96:111], v[56:59], v[228:231], v[96:111]
    ds_read_b64_tr_b16 v[40:41], v28 offset:40960
    ds_read_b64_tr_b16 v[42:43], v29 offset:43008
    v_exp_f32 v163, v163
    v_fma_f32 v164, v164, s64, -v2
    v_fma_f32 v165, v165, s64, -v2
    s_waitcnt lgkmcnt(6)
    v_mfma_f32_32x32x16_bf16 v[112:127], v[60:63], v[228:231], v[112:127]
    ds_read_b64_tr_b16 v[44:45], v30 offset:40960
    ds_read_b64_tr_b16 v[46:47], v31 offset:43008
    v_fma_f32 v166, v166, s64, -v2
    v_fma_f32 v167, v167, s64, -v2
    v_exp_f32 v164, v164
    v_exp_f32 v165, v165
    s_waitcnt lgkmcnt(6)
    v_mfma_f32_32x32x16_bf16 v[64:79], v[32:35], v[232:235], v[64:79]
    ds_read_b64_tr_b16 v[48:49], v24 offset:45056
    ds_read_b64_tr_b16 v[50:51], v25 offset:47104
    v_exp_f32 v166, v166
    v_exp_f32 v167, v167
    v_add_f32 v9, v160, v161
    s_waitcnt lgkmcnt(6)
    v_mfma_f32_32x32x16_bf16 v[80:95], v[36:39], v[232:235], v[80:95]
    ds_read_b64_tr_b16 v[52:53], v26 offset:45056
    ds_read_b64_tr_b16 v[54:55], v27 offset:47104
    v_add_f32 v10, v162, v163
    v_fma_f32 v168, v168, s64, -v2
    v_fma_f32 v169, v169, s64, -v2
    v_fma_f32 v170, v170, s64, -v2
    v_fma_f32 v171, v171, s64, -v2
    s_waitcnt lgkmcnt(6)
    v_mfma_f32_32x32x16_bf16 v[96:111], v[40:43], v[232:235], v[96:111]
    ds_read_b64_tr_b16 v[56:57], v28 offset:45056
    ds_read_b64_tr_b16 v[58:59], v29 offset:47104
    v_exp_f32 v168, v168
    v_exp_f32 v169, v169
    v_exp_f32 v170, v170
    s_waitcnt lgkmcnt(6)
    v_mfma_f32_32x32x16_bf16 v[112:127], v[44:47], v[232:235], v[112:127]
    ds_read_b64_tr_b16 v[60:61], v30 offset:45056
    ds_read_b64_tr_b16 v[62:63], v31 offset:47104
    v_exp_f32 v171, v171
    v_add_f32 v9, v9, v164
    v_add_f32 v10, v10, v165
    s_waitcnt lgkmcnt(6)
    v_mfma_f32_32x32x16_bf16 v[64:79], v[48:51], v[236:239], v[64:79]
    ds_read_b128 v[32:35], v16 offset:0
    v_add_f32 v9, v9, v166
    v_add_f32 v10, v10, v167
    v_fma_f32 v172, v172, s64, -v2
    v_fma_f32 v173, v173, s64, -v2
    v_fma_f32 v174, v174, s64, -v2
    v_fma_f32 v175, v175, s64, -v2
    s_waitcnt lgkmcnt(5)
    v_mfma_f32_32x32x16_bf16 v[80:95], v[52:55], v[236:239], v[80:95]
    ds_read_b128 v[36:39], v17 offset:0
    v_exp_f32 v172, v172
    v_exp_f32 v173, v173
    v_exp_f32 v174, v174
    s_waitcnt lgkmcnt(4)
    v_mfma_f32_32x32x16_bf16 v[96:111], v[56:59], v[236:239], v[96:111]
    ds_read_b128 v[40:43], v18 offset:0
    v_exp_f32 v175, v175
    v_add_f32 v9, v9, v168
    v_add_f32 v10, v10, v169
    s_waitcnt lgkmcnt(3)
    v_mfma_f32_32x32x16_bf16 v[112:127], v[60:63], v[236:239], v[112:127]
    ds_read_b128 v[44:47], v19 offset:0
    v_add_f32 v9, v9, v170
    v_add_f32 v10, v10, v171
    v_fma_f32 v176, v176, s64, -v2
    v_fma_f32 v177, v177, s64, -v2
    v_fma_f32 v178, v178, s64, -v2
    s_waitcnt lgkmcnt(3)
    v_mfma_f32_32x32x16_bf16 v[128:143], v[32:35], v[192:195], 0
    ds_read_b128 v[48:51], v20 offset:0
    v_fma_f32 v179, v179, s64, -v2
    v_exp_f32 v176, v176
    v_exp_f32 v177, v177
    v_exp_f32 v178, v178
    s_waitcnt lgkmcnt(3)
    v_mfma_f32_32x32x16_bf16 v[128:143], v[36:39], v[196:199], v[128:143]
    ds_read_b128 v[52:55], v21 offset:0
    v_exp_f32 v179, v179
    v_add_f32 v9, v9, v172
    v_add_f32 v10, v10, v173
    s_waitcnt lgkmcnt(3)
    v_mfma_f32_32x32x16_bf16 v[128:143], v[40:43], v[200:203], v[128:143]
    ds_read_b128 v[56:59], v22 offset:0
    v_add_f32 v9, v9, v174
    v_add_f32 v10, v10, v175
    v_fma_f32 v180, v180, s64, -v2
    v_fma_f32 v181, v181, s64, -v2
    v_fma_f32 v182, v182, s64, -v2
    s_waitcnt lgkmcnt(3)
    v_mfma_f32_32x32x16_bf16 v[128:143], v[44:47], v[204:207], v[128:143]
    ds_read_b128 v[60:63], v23 offset:0
    v_fma_f32 v183, v183, s64, -v2
    v_exp_f32 v180, v180
    v_exp_f32 v181, v181
    s_waitcnt lgkmcnt(3)
    v_mfma_f32_32x32x16_bf16 v[128:143], v[48:51], v[208:211], v[128:143]
    ds_read_b128 v[32:35], v16 offset:8192
    v_exp_f32 v182, v182
    v_exp_f32 v183, v183
    v_add_f32 v9, v9, v176
    v_add_f32 v10, v10, v177
    s_waitcnt lgkmcnt(3)
    v_mfma_f32_32x32x16_bf16 v[128:143], v[52:55], v[212:215], v[128:143]
    ds_read_b128 v[36:39], v17 offset:8192
    v_add_f32 v9, v9, v178
    v_add_f32 v10, v10, v179
    v_fma_f32 v184, v184, s64, -v2
    v_fma_f32 v185, v185, s64, -v2
    v_fma_f32 v186, v186, s64, -v2
    s_waitcnt lgkmcnt(3)
    v_mfma_f32_32x32x16_bf16 v[128:143], v[56:59], v[216:219], v[128:143]
    ds_read_b128 v[40:43], v18 offset:8192
    v_fma_f32 v187, v187, s64, -v2
    v_exp_f32 v184, v184
    v_exp_f32 v185, v185
    s_waitcnt lgkmcnt(3)
    v_mfma_f32_32x32x16_bf16 v[128:143], v[60:63], v[220:223], v[128:143]
    ds_read_b128 v[44:47], v19 offset:8192
    v_exp_f32 v186, v186
    v_exp_f32 v187, v187
    v_add_f32 v9, v9, v180
    s_waitcnt lgkmcnt(3)
    v_mfma_f32_32x32x16_bf16 v[144:159], v[32:35], v[192:195], 0
    ds_read_b128 v[48:51], v20 offset:8192
    v_add_f32 v10, v10, v181
    v_add_f32 v9, v9, v182
    v_add_f32 v10, v10, v183
    v_fma_f32 v188, v188, s64, -v2
    v_fma_f32 v189, v189, s64, -v2
    v_fma_f32 v190, v190, s64, -v2
    s_waitcnt lgkmcnt(3)
    v_mfma_f32_32x32x16_bf16 v[144:159], v[36:39], v[196:199], v[144:159]
    ds_read_b128 v[52:55], v21 offset:8192
    v_fma_f32 v191, v191, s64, -v2
    v_exp_f32 v188, v188
    v_exp_f32 v189, v189
    s_waitcnt lgkmcnt(3)
    v_mfma_f32_32x32x16_bf16 v[144:159], v[40:43], v[200:203], v[144:159]
    ds_read_b128 v[56:59], v22 offset:8192
    v_exp_f32 v190, v190
    v_exp_f32 v191, v191
    v_add_f32 v9, v9, v184
    s_waitcnt lgkmcnt(3)
    v_mfma_f32_32x32x16_bf16 v[144:159], v[44:47], v[204:207], v[144:159]
    ds_read_b128 v[60:63], v23 offset:8192
    v_add_f32 v10, v10, v185
    v_add_f32 v9, v9, v186
    v_add_f32 v10, v10, v187
    v_mov_b32 v6, v6
    v_add_f32 v9, v9, v188
    s_waitcnt lgkmcnt(3)
    v_mfma_f32_32x32x16_bf16 v[144:159], v[48:51], v[208:211], v[144:159]
    v_add_f32 v10, v10, v189
    v_add_f32 v9, v9, v190
    v_add_f32 v10, v10, v191
    v_add_f32 v9, v9, v10
    v_add_f32 v3, v3, v9
    v_cvt_pk_bf16_f32 v224, v160, v161
    s_waitcnt lgkmcnt(2)
    v_mfma_f32_32x32x16_bf16 v[144:159], v[52:55], v[212:215], v[144:159]
    v_cvt_pk_bf16_f32 v225, v162, v163
    v_cvt_pk_bf16_f32 v226, v164, v165
    v_cvt_pk_bf16_f32 v227, v166, v167
    v_cvt_pk_bf16_f32 v228, v168, v169
    v_cvt_pk_bf16_f32 v229, v170, v171
    s_waitcnt lgkmcnt(1)
    v_mfma_f32_32x32x16_bf16 v[144:159], v[56:59], v[216:219], v[144:159]
    v_cvt_pk_bf16_f32 v230, v172, v173
    v_cvt_pk_bf16_f32 v231, v174, v175
    v_cvt_pk_bf16_f32 v232, v176, v177
    v_cvt_pk_bf16_f32 v233, v178, v179
    v_cvt_pk_bf16_f32 v234, v180, v181
    s_waitcnt lgkmcnt(0)
    v_mfma_f32_32x32x16_bf16 v[144:159], v[60:63], v[220:223], v[144:159]
    v_cvt_pk_bf16_f32 v235, v182, v183
    v_cvt_pk_bf16_f32 v236, v184, v185
    v_cvt_pk_bf16_f32 v237, v186, v187
    v_cvt_pk_bf16_f32 v238, v188, v189
    v_cvt_pk_bf16_f32 v239, v190, v191
    s_add_u32 s60, s60, 1
    s_cmp_eq_u32 s60, s59
    s_cbranch_scc1 L_L0
    s_waitcnt vmcnt(0)
    s_barrier
    ds_read_b64_tr_b16 v[32:33], v24 offset:49152
    ds_read_b64_tr_b16 v[34:35], v25 offset:51200
    ds_read_b64_tr_b16 v[36:37], v26 offset:49152
    ds_read_b64_tr_b16 v[38:39], v27 offset:51200
    ds_read_b64_tr_b16 v[40:41], v28 offset:49152
    ds_read_b64_tr_b16 v[42:43], v29 offset:51200
    ds_read_b64_tr_b16 v[44:45], v30 offset:49152
    ds_read_b64_tr_b16 v[46:47], v31 offset:51200
    s_cmp_eq_u32 s63, 0
    s_cbranch_scc1 L_noo_M0
    v_mul_f32 v64, v64, v4
    v_mul_f32 v65, v65, v4
    v_mul_f32 v66, v66, v4
    v_mul_f32 v67, v67, v4
    v_mul_f32 v68, v68, v4
    v_mul_f32 v69, v69, v4
    v_mul_f32 v70, v70, v4
    v_mul_f32 v71, v71, v4
    v_mul_f32 v72, v72, v4
    v_mul_f32 v73, v73, v4
    v_mul_f32 v74, v74, v4
    v_mul_f32 v75, v75, v4
    v_mul_f32 v76, v76, v4
    v_mul_f32 v77, v77, v4
    v_mul_f32 v78, v78, v4
    v_mul_f32 v79, v79, v4
    v_mul_f32 v80, v80, v4
    v_mul_f32 v81, v81, v4
    v_mul_f32 v82, v82, v4
    v_mul_f32 v83, v83, v4
    v_mul_f32 v84, v84, v4
    v_mul_f32 v85, v85, v4
    v_mul_f32 v86, v86, v4
    v_mul_f32 v87, v87, v4
    v_mul_f32 v88, v88, v4
    v_mul_f32 v89, v89, v4
    v_mul_f32 v90, v90, v4
    v_mul_f32 v91, v91, v4
    v_mul_f32 v92, v92, v4
    v_mul_f32 v93, v93, v4
    v_mul_f32 v94, v94, v4
    v_mul_f32 v95, v95, v4
    v_mul_f32 v96, v96, v4
    v_mul_f32 v97, v97, v4
    v_mul_f32 v98, v98, v4
    v_mul_f32 v99, v99, v4
    v_mul_f32 v100, v100, v4
    v_mul_f32 v101, v101, v4
    v_mul_f32 v102, v102, v4
    v_mul_f32 v103, v103, v4
    v_mul_f32 v104, v104, v4
    v_mul_f32 v105, v105, v4
    v_mul_f32 v106, v106, v4
    v_mul_f32 v107, v107, v4
    v_mul_f32 v108, v108, v4
    v_mul_f32 v109, v109, v4
    v_mul_f32 v110, v110, v4
    v_mul_f32 v111, v111, v4
    v_mul_f32 v112, v112, v4
    v_mul_f32 v113, v113, v4
    v_mul_f32 v114, v114, v4
    v_mul_f32 v115, v115, v4
    v_mul_f32 v116, v116, v4
    v_mul_f32 v117, v117, v4
    v_mul_f32 v118, v118, v4
    v_mul_f32 v119, v119, v4
    v_mul_f32 v120, v120, v4
    v_mul_f32 v121, v121, v4
    v_mul_f32 v122, v122, v4
    v_mul_f32 v123, v123, v4
    v_mul_f32 v124, v124, v4
    v_mul_f32 v125, v125, v4
    v_mul_f32 v126, v126, v4
    v_mul_f32 v127, v127, v4
    s_mov_b32 s63, 0
    s_nop 1
L_noo_M0:
    s_add_u32 s3, s60, 2
    s_cmp_lt_u32 s3, s58
    s_cbranch_scc0 L_nok_M0
    s_add_u32 s62, s61, 262144
    s_add_u32 m0, s65, 0
    s_nop 0
    buffer_load_dwordx4 v12, s[20:23], s62 offen offset:0 lds
    buffer_load_dwordx4 v13, s[20:23], s62 offen offset:1024 lds
    buffer_load_dwordx4 v14, s[20:23], s62 offen offset:2048 lds
    buffer_load_dwordx4 v15, s[20:23], s62 offen offset:3072 lds
L_nok_M0:
    s_add_u32 m0, s65, 32768
    s_nop 0
    buffer_load_dwordx4 v12, s[24:27], s61 offen offset:0 lds
    buffer_load_dwordx4 v13, s[24:27], s61 offen offset:1024 lds
    buffer_load_dwordx4 v14, s[24:27], s61 offen offset:2048 lds
    buffer_load_dwordx4 v15, s[24:27], s61 offen offset:3072 lds
    s_add_u32 s61, s61, 131072
    v_max3_f32 v5, v128, v129, v130
    v_max3_f32 v6, v131, v132, v133
    v_max3_f32 v7, v134, v135, v136
    v_max3_f32 v8, v137, v138, v139
    v_max3_f32 v5, v5, v140, v141
    v_max3_f32 v6, v6, v142, v143
    v_max3_f32 v7, v7, v144, v145
    v_max3_f32 v8, v8, v146, v147
    s_waitcnt lgkmcnt(6)
    v_mfma_f32_32x32x16_bf16 v[64:79], v[32:35], v[224:227], v[64:79]
    ds_read_b64_tr_b16 v[48:49], v24 offset:53248
    ds_read_b64_tr_b16 v[50:51], v25 offset:55296
    v_max3_f32 v5, v5, v148, v149
    v_max3_f32 v6, v6, v150, v151
    v_max3_f32 v7, v7, v152, v153
    v_max3_f32 v8, v8, v154, v155
    v_max3_f32 v5, v5, v156, v157
    v_max3_f32 v6, v6, v158, v159
    s_waitcnt lgkmcnt(6)
    v_mfma_f32_32x32x16_bf16 v[80:95], v[36:39], v[224:227], v[80:95]
    ds_read_b64_tr_b16 v[52:53], v26 offset:53248
    ds_read_b64_tr_b16 v[54:55], v27 offset:55296
    v_max3_f32 v5, v5, v6, v7
    v_max_f32 v5, v5, v8
    v_mov_b32 v6, v5
    s_nop 1
    v_permlane32_swap_b32 v5, v6
    v_max_f32 v5, v5, v6
    v_mul_f32 v5, s64, v5
    v_sub_f32 v6, v5, v2
    v_cmp_lt_f32 vcc, 0x41000000, v6
    s_cbranch_vccz L_nors_M0
    v_max_f32 v7, v2, v5
    v_sub_f32 v8, v2, v7
    v_exp_f32 v4, v8
    v_mov_b32 v2, v7
    s_mov_b32 s63, 1
    v_mul_f32 v3, v3, v4
L_nors_M0:
    s_waitcnt lgkmcnt(6)
    v_mfma_f32_32x32x16_bf16 v[96:111], v[40:43], v[224:227], v[96:111]
    ds_read_b64_tr_b16 v[56:57], v28 offset:53248
    ds_read_b64_tr_b16 v[58:59], v29 offset:55296
    s_waitcnt lgkmcnt(6)
    v_mfma_f32_32x32x16_bf16 v[112:127], v[44:47], v[224:227], v[112:127]
    ds_read_b64_tr_b16 v[60:61], v30 offset:53248
    ds_read_b64_tr_b16 v[62:63], v31 offset:55296
    s_waitcnt lgkmcnt(6)
    v_mfma_f32_32x32x16_bf16 v[64:79], v[48:51], v[228:231], v[64:79]
    ds_read_b64_tr_b16 v[32:33], v24 offset:57344
    ds_read_b64_tr_b16 v[34:35], v25 offset:59392
    v_fma_f32 v128, v128, s64, -v2
    v_fma_f32 v129, v129, s64, -v2
    v_fma_f32 v130, v130, s64, -v2
    v_fma_f32 v131, v131, s64, -v2
    s_waitcnt lgkmcnt(6)
    v_mfma_f32_32x32x16_bf16 v[80:95], v[52:55], v[228:231], v[80:95]
    ds_read_b64_tr_b16 v[36:37], v26 offset:57344
    ds_read_b64_tr_b16 v[38:39], v27 offset:59392
    v_exp_f32 v128, v128
    v_exp_f32 v129, v129
    v_exp_f32 v130, v130
    s_waitcnt lgkmcnt(6)
    v_mfma_f32_32x32x16_bf16 v[96:111], v[56:59], v[228:231], v[96:111]
    ds_read_b64_tr_b16 v[40:41], v28 offset:57344
    ds_read_b64_tr_b16 v[42:43], v29 offset:59392
    v_exp_f32 v131, v131
    v_fma_f32 v132, v132, s64, -v2
    v_fma_f32 v133, v133, s64, -v2
    s_waitcnt lgkmcnt(6)
    v_mfma_f32_32x32x16_bf16 v[112:127], v[60:63], v[228:231], v[112:127]
    ds_read_b64_tr_b16 v[44:45], v30 offset:57344
    ds_read_b64_tr_b16 v[46:47], v31 offset:59392
    v_fma_f32 v134, v134, s64, -v2
    v_fma_f32 v135, v135, s64, -v2
    v_exp_f32 v132, v132
    v_exp_f32 v133, v133
    s_waitcnt lgkmcnt(6)
    v_mfma_f32_32x32x16_bf16 v[64:79], v[32:35], v[232:235], v[64:79]
    ds_read_b64_tr_b16 v[48:49], v24 offset:61440
    ds_read_b64_tr_b16 v[50:51], v25 offset:63488
    v_exp_f32 v134, v134
    v_exp_f32 v135, v135
    v_add_f32 v9, v128, v129
    s_waitcnt lgkmcnt(6)
    v_mfma_f32_32x32x16_bf16 v[80:95], v[36:39], v[232:235], v[80:95]
    ds_read_b64_tr_b16 v[52:53], v26 offset:61440
    ds_read_b64_tr_b16 v[54:55], v27 offset:63488
    v_add_f32 v10, v130, v131
    v_fma_f32 v136, v136, s64, -v2
    v_fma_f32 v137, v137, s64, -v2
    v_fma_f32 v138, v138, s64, -v2
    v_fma_f32 v139, v139, s64, -v2
    s_waitcnt lgkmcnt(6)
    v_mfma_f32_32x32x16_bf16 v[96:111], v[40:43], v[232:235], v[96:111]
    ds_read_b64_tr_b16 v[56:57], v28 offset:61440
    ds_read_b64_tr_b16 v[58:59], v29 offset:63488
    v_exp_f32 v136, v136
    v_exp_f32 v137, v137
    v_exp_f32 v138, v138
    s_waitcnt lgkmcnt(6)
    v_mfma_f32_32x32x16_bf16 v[112:127], v[44:47], v[232:235], v[112:127]
    ds_read_b64_tr_b16 v[60:61], v30 offset:61440
    ds_read_b64_tr_b16 v[62:63], v31 offset:63488
    v_exp_f32 v139, v139
    v_add_f32 v9, v9, v132
    v_add_f32 v10, v10, v133
    s_waitcnt lgkmcnt(6)
    v_mfma_f32_32x32x16_bf16 v[64:79], v[48:51], v[236:239], v[64:79]
    ds_read_b128 v[32:35], v16 offset:16384
    v_add_f32 v9, v9, v134
    v_add_f32 v10, v10, v135
    v_fma_f32 v140, v140, s64, -v2
    v_fma_f32 v141, v141, s64, -v2
    v_fma_f32 v142, v142, s64, -v2
    v_fma_f32 v143, v143, s64, -v2
    s_waitcnt lgkmcnt(5)
    v_mfma_f32_32x32x16_bf16 v[80:95], v[52:55], v[236:239], v[80:95]
    ds_read_b128 v[36:39], v17 offset:16384
    v_exp_f32 v140, v140
    v_exp_f32 v141, v141
    v_exp_f32 v142, v142
    s_waitcnt lgkmcnt(4)
    v_mfma_f32_32x32x16_bf16 v[96:111], v[56:59], v[236:239], v[96:111]
    ds_read_b128 v[40:43], v18 offset:16384
    v_exp_f32 v143, v143
    v_add_f32 v9, v9, v136
    v_add_f32 v10, v10, v137
    s_waitcnt lgkmcnt(3)
    v_mfma_f32_32x32x16_bf16 v[112:127], v[60:63], v[236:239], v[112:127]
    ds_read_b128 v[44:47], v19 offset:16384
    v_add_f32 v9, v9, v138
    v_add_f32 v10, v10, v139
    v_fma_f32 v144, v144, s64, -v2
    v_fma_f32 v145, v145, s64, -v2
    v_fma_f32 v146, v146, s64, -v2
    s_waitcnt lgkmcnt(3)
    v_mfma_f32_32x32x16_bf16 v[160:175], v[32:35], v[192:195], 0
    ds_read_b128 v[48:51], v20 offset:16384
    v_fma_f32 v147, v147, s64, -v2
    v_exp_f32 v144, v144
    v_exp_f32 v145, v145
    v_exp_f32 v146, v146
    s_waitcnt lgkmcnt(3)
    v_mfma_f32_32x32x16_bf16 v[160:175], v[36:39], v[196:199], v[160:175]
    ds_read_b128 v[52:55], v21 offset:16384
    v_exp_f32 v147, v147
    v_add_f32 v9, v9, v140
    v_add_f32 v10, v10, v141
    s_waitcnt lgkmcnt(3)
    v_mfma_f32_32x32x16_bf16 v[160:175], v[40:43], v[200:203], v[160:175]
    ds_read_b128 v[56:59], v22 offset:16384
    v_add_f32 v9, v9, v142
    v_add_f32 v10, v10, v143
    v_fma_f32 v148, v148, s64, -v2
    v_fma_f32 v149, v149, s64, -v2
    v_fma_f32 v150, v150, s64, -v2
    s_waitcnt lgkmcnt(3)
    v_mfma_f32_32x32x16_bf16 v[160:175], v[44:47], v[204:207], v[160:175]
    ds_read_b128 v[60:63], v23 offset:16384
    v_fma_f32 v151, v151, s64, -v2
    v_exp_f32 v148, v148
    v_exp_f32 v149, v149
    s_waitcnt lgkmcnt(3)
    v_mfma_f32_32x32x16_bf16 v[160:175], v[48:51], v[208:211], v[160:175]
    ds_read_b128 v[32:35], v16 offset:24576
    v_exp_f32 v150, v150
    v_exp_f32 v151, v151
    v_add_f32 v9, v9, v144
    v_add_f32 v10, v10, v145
    s_waitcnt lgkmcnt(3)
    v_mfma_f32_32x32x16_bf16 v[160:175], v[52:55], v[212:215], v[160:175]
    ds_read_b128 v[36:39], v17 offset:24576
    v_add_f32 v9, v9, v146
    v_add_f32 v10, v10, v147
    v_fma_f32 v152, v152, s64, -v2
    v_fma_f32 v153, v153, s64, -v2
    v_fma_f32 v154, v154, s64, -v2
    s_waitcnt lgkmcnt(3)
    v_mfma_f32_32x32x16_bf16 v[160:175], v[56:59], v[216:219], v[160:175]
    ds_read_b128 v[40:43], v18 offset:24576
    v_fma_f32 v155, v155, s64, -v2
    v_exp_f32 v152, v152
    v_exp_f32 v153, v153
    s_waitcnt lgkmcnt(3)
    v_mfma_f32_32x32x16_bf16 v[160:175], v[60:63], v[220:223], v[160:175]
    ds_read_b128 v[44:47], v19 offset:24576
    v_exp_f32 v154, v154
    v_exp_f32 v155, v155
    v_add_f32 v9, v9, v148
    s_waitcnt lgkmcnt(3)
    v_mfma_f32_32x32x16_bf16 v[176:191], v[32:35], v[192:195], 0
    ds_read_b128 v[48:51], v20 offset:24576
    v_add_f32 v10, v10, v149
    v_add_f32 v9, v9, v150
    v_add_f32 v10, v10, v151
    v_fma_f32 v156, v156, s64, -v2
    v_fma_f32 v157, v157, s64, -v2
    v_fma_f32 v158, v158, s64, -v2
    s_waitcnt lgkmcnt(3)
    v_mfma_f32_32x32x16_bf16 v[176:191], v[36:39], v[196:199], v[176:191]
    ds_read_b128 v[52:55], v21 offset:24576
    v_fma_f32 v159, v159, s64, -v2
    v_exp_f32 v156, v156
    v_exp_f32 v157, v157
    s_waitcnt lgkmcnt(3)
    v_mfma_f32_32x32x16_bf16 v[176:191], v[40:43], v[200:203], v[176:191]
    ds_read_b128 v[56:59], v22 offset:24576
    v_exp_f32 v158, v158
    v_exp_f32 v159, v159
    v_add_f32 v9, v9, v152
    s_waitcnt lgkmcnt(3)
    v_mfma_f32_32x32x16_bf16 v[176:191], v[44:47], v[204:207], v[176:191]
    ds_read_b128 v[60:63], v23 offset:24576
    v_add_f32 v10, v10, v153
    v_add_f32 v9, v9, v154
    v_add_f32 v10, v10, v155
    v_mov_b32 v6, v6
    v_add_f32 v9, v9, v156
    s_waitcnt lgkmcnt(3)
    v_mfma_f32_32x32x16_bf16 v[176:191], v[48:51], v[208:211], v[176:191]
    v_add_f32 v10, v10, v157
    v_add_f32 v9, v9, v158
    v_add_f32 v10, v10, v159
    v_add_f32 v9, v9, v10
    v_add_f32 v3, v3, v9
    v_cvt_pk_bf16_f32 v224, v128, v129
    s_waitcnt lgkmcnt(2)
    v_mfma_f32_32x32x16_bf16 v[176:191], v[52:55], v[212:215], v[176:191]
    v_cvt_pk_bf16_f32 v225, v130, v131
    v_cvt_pk_bf16_f32 v226, v132, v133
    v_cvt_pk_bf16_f32 v227, v134, v135
    v_cvt_pk_bf16_f32 v228, v136, v137
    v_cvt_pk_bf16_f32 v229, v138, v139
    s_waitcnt lgkmcnt(1)
    v_mfma_f32_32x32x16_bf16 v[176:191], v[56:59], v[216:219], v[176:191]
    v_cvt_pk_bf16_f32 v230, v140, v141
    v_cvt_pk_bf16_f32 v231, v142, v143
    v_cvt_pk_bf16_f32 v232, v144, v145
    v_cvt_pk_bf16_f32 v233, v146, v147
    v_cvt_pk_bf16_f32 v234, v148, v149
    s_waitcnt lgkmcnt(0)
    v_mfma_f32_32x32x16_bf16 v[176:191], v[60:63], v[220:223], v[176:191]
    v_cvt_pk_bf16_f32 v235, v150, v151
    v_cvt_pk_bf16_f32 v236, v152, v153
    v_cvt_pk_bf16_f32 v237, v154, v155
    v_cvt_pk_bf16_f32 v238, v156, v157
    v_cvt_pk_bf16_f32 v239, v158, v159
    s_add_u32 s60, s60, 1
    s_branch L_odd
L_L1:
    s_waitcnt vmcnt(0)
    s_barrier
    ds_read_b64_tr_b16 v[32:33], v24 offset:32768
    ds_read_b64_tr_b16 v[34:35], v25 offset:34816
    ds_read_b64_tr_b16 v[36:37], v26 offset:32768
    ds_read_b64_tr_b16 v[38:39], v27 offset:34816
    ds_read_b64_tr_b16 v[40:41], v28 offset:32768
    ds_read_b64_tr_b16 v[42:43], v29 offset:34816
    ds_read_b64_tr_b16 v[44:45], v30 offset:32768
    ds_read_b64_tr_b16 v[46:47], v31 offset:34816
    s_cmp_eq_u32 s63, 0
    s_cbranch_scc1 L_noo_L1
    v_mul_f32 v64, v64, v4
    v_mul_f32 v65, v65, v4
    v_mul_f32 v66, v66, v4
    v_mul_f32 v67, v67, v4
    v_mul_f32 v68, v68, v4
    v_mul_f32 v69, v69, v4
    v_mul_f32 v70, v70, v4
    v_mul_f32 v71, v71, v4
    v_mul_f32 v72, v72, v4
    v_mul_f32 v73, v73, v4
    v_mul_f32 v74, v74, v4
    v_mul_f32 v75, v75, v4
    v_mul_f32 v76, v76, v4
    v_mul_f32 v77, v77, v4
    v_mul_f32 v78, v78, v4
    v_mul_f32 v79, v79, v4
    v_mul_f32 v80, v80, v4
    v_mul_f32 v81, v81, v4
    v_mul_f32 v82, v82, v4
    v_mul_f32 v83, v83, v4
    v_mul_f32 v84, v84, v4
    v_mul_f32 v85, v85, v4
    v_mul_f32 v86, v86, v4
    v_mul_f32 v87, v87, v4
    v_mul_f32 v88, v88, v4
    v_mul_f32 v89, v89, v4
    v_mul_f32 v90, v90, v4
    v_mul_f32 v91, v91, v4
    v_mul_f32 v92, v92, v4
    v_mul_f32 v93, v93, v4
    v_mul_f32 v94, v94, v4
    v_mul_f32 v95, v95, v4
    v_mul_f32 v96, v96, v4
    v_mul_f32 v97, v97, v4
    v_mul_f32 v98, v98, v4
    v_mul_f32 v99, v99, v4
    v_mul_f32 v100, v100, v4
    v_mul_f32 v101, v101, v4
    v_mul_f32 v102, v102, v4
    v_mul_f32 v103, v103, v4
    v_mul_f32 v104, v104, v4
    v_mul_f32 v105, v105, v4
    v_mul_f32 v106, v106, v4
    v_mul_f32 v107, v107, v4
    v_mul_f32 v108, v108, v4
    v_mul_f32 v109, v109, v4
    v_mul_f32 v110, v110, v4
    v_mul_f32 v111, v111, v4
    v_mul_f32 v112, v112, v4
    v_mul_f32 v113, v113, v4
    v_mul_f32 v114, v114, v4
    v_mul_f32 v115, v115, v4
    v_mul_f32 v116, v116, v4
    v_mul_f32 v117, v117, v4
    v_mul_f32 v118, v118, v4
    v_mul_f32 v119, v119, v4
    v_mul_f32 v120, v120, v4
    v_mul_f32 v121, v121, v4
    v_mul_f32 v122, v122, v4
    v_mul_f32 v123, v123, v4
    v_mul_f32 v124, v124, v4
    v_mul_f32 v125, v125, v4
    v_mul_f32 v126, v126, v4
    v_mul_f32 v127, v127, v4
    s_mov_b32 s63, 0
    s_nop 1
L_noo_L1:
    s_add_u32 m0, s65, 49152
    s_nop 0
    buffer_load_dwordx4 v12, s[24:27], s61 offen offset:0 lds
    buffer_load_dwordx4 v13, s[24:27], s61 offen offset:1024 lds
    buffer_load_dwordx4 v14, s[24:27], s61 offen offset:2048 lds
    buffer_load_dwordx4 v15, s[24:27], s61 offen offset:3072 lds
    s_add_u32 s61, s61, 131072
    v_mov_b32 v10, 0xff800000
    v_cmp_gt_i32 s[70:71], 0, v240
    v_cmp_gt_i32 s[72:73], 1, v240
    v_cmp_gt_i32 s[74:75], 2, v240
    v_cmp_gt_i32 s[76:77], 3, v240
    v_cndmask_b32 v160, v160, v10, s[70:71]
    v_cndmask_b32 v161, v161, v10, s[72:73]
    v_cndmask_b32 v162, v162, v10, s[74:75]
    v_cndmask_b32 v163, v163, v10, s[76:77]
    v_cmp_gt_i32 s[70:71], 8, v240
    v_cmp_gt_i32 s[72:73], 9, v240
    v_cmp_gt_i32 s[74:75], 10, v240
    v_cmp_gt_i32 s[76:77], 11, v240
    v_cndmask_b32 v164, v164, v10, s[70:71]
    v_cndmask_b32 v165, v165, v10, s[72:73]
    v_cndmask_b32 v166, v166, v10, s[74:75]
    v_cndmask_b32 v167, v167, v10, s[76:77]
    v_cmp_gt_i32 s[70:71], 16, v240
    v_cmp_gt_i32 s[72:73], 17, v240
    v_cmp_gt_i32 s[74:75], 18, v240
    v_cmp_gt_i32 s[76:77], 19, v240
    v_cndmask_b32 v168, v168, v10, s[70:71]
    v_cndmask_b32 v169, v169, v10, s[72:73]
    v_cndmask_b32 v170, v170, v10, s[74:75]
    v_cndmask_b32 v171, v171, v10, s[76:77]
    s_waitcnt lgkmcnt(6)
    v_mfma_f32_32x32x16_bf16 v[64:79], v[32:35], v[224:227], v[64:79]
    ds_read_b64_tr_b16 v[48:49], v24 offset:36864
    ds_read_b64_tr_b16 v[50:51], v25 offset:38912
    v_cmp_gt_i32 s[70:71], 24, v240
    v_cmp_gt_i32 s[72:73], 25, v240
    v_cmp_gt_i32 s[74:75], 26, v240
    v_cmp_gt_i32 s[76:77], 27, v240
    v_cndmask_b32 v172, v172, v10, s[70:71]
    v_cndmask_b32 v173, v173, v10, s[72:73]
    v_cndmask_b32 v174, v174, v10, s[74:75]
    v_cndmask_b32 v175, v175, v10, s[76:77]
    s_waitcnt lgkmcnt(6)
    v_mfma_f32_32x32x16_bf16 v[80:95], v[36:39], v[224:227], v[80:95]
    ds_read_b64_tr_b16 v[52:53], v26 offset:36864
    ds_read_b64_tr_b16 v[54:55], v27 offset:38912
    v_cmp_gt_i32 s[70:71], 32, v240
    v_cmp_gt_i32 s[72:73], 33, v240
    v_cmp_gt_i32 s[74:75], 34, v240
    v_cmp_gt_i32 s[76:77], 35, v240
    v_cndmask_b32 v176, v176, v10, s[70:71]
    v_cndmask_b32 v177, v177, v10, s[72:73]
    v_cndmask_b32 v178, v178, v10, s[74:75]
    v_cndmask_b32 v179, v179, v10, s[76:77]
    v_cmp_gt_i32 s[70:71], 40, v240
    v_cmp_gt_i32 s[72:73], 41, v240
    v_cmp_gt_i32 s[74:75], 42, v240
    v_cmp_gt_i32 s[76:77], 43, v240
    v_cndmask_b32 v180, v180, v10, s[70:71]
    v_cndmask_b32 v181, v181, v10, s[72:73]
    v_cndmask_b32 v182, v182, v10, s[74:75]
    v_cndmask_b32 v183, v183, v10, s[76:77]
    s_waitcnt lgkmcnt(6)
    v_mfma_f32_32x32x16_bf16 v[96:111], v[40:43], v[224:227], v[96:111]
    ds_read_b64_tr_b16 v[56:57], v28 offset:36864
    ds_read_b64_tr_b16 v[58:59], v29 offset:38912
    v_cmp_gt_i32 s[70:71], 48, v240
    v_cmp_gt_i32 s[72:73], 49, v240
    v_cmp_gt_i32 s[74:75], 50, v240
    v_cmp_gt_i32 s[76:77], 51, v240
    v_cndmask_b32 v184, v184, v10, s[70:71]
    v_cndmask_b32 v185, v185, v10, s[72:73]
    v_cndmask_b32 v186, v186, v10, s[74:75]
    v_cndmask_b32 v187, v187, v10, s[76:77]
    v_cmp_gt_i32 s[70:71], 56, v240
    v_cmp_gt_i32 s[72:73], 57, v240
    v_cmp_gt_i32 s[74:75], 58, v240
    v_cmp_gt_i32 s[76:77], 59, v240
    v_cndmask_b32 v188, v188, v10, s[70:71]
    v_cndmask_b32 v189, v189, v10, s[72:73]
    v_cndmask_b32 v190, v190, v10, s[74:75]
    v_cndmask_b32 v191, v191, v10, s[76:77]
    s_waitcnt lgkmcnt(6)
    v_mfma_f32_32x32x16_bf16 v[112:127], v[44:47], v[224:227], v[112:127]
    ds_read_b64_tr_b16 v[60:61], v30 offset:36864
    ds_read_b64_tr_b16 v[62:63], v31 offset:38912
    v_max3_f32 v5, v160, v161, v162
    v_max3_f32 v6, v163, v164, v165
    v_max3_f32 v7, v166, v167, v168
    v_max3_f32 v8, v169, v170, v171
    v_max3_f32 v5, v5, v172, v173
    v_max3_f32 v6, v6, v174, v175
    v_max3_f32 v7, v7, v176, v177
    v_max3_f32 v8, v8, v178, v179
    v_max3_f32 v5, v5, v180, v181
    v_max3_f32 v6, v6, v182, v183
    s_waitcnt lgkmcnt(6)
    v_mfma_f32_32x32x16_bf16 v[64:79], v[48:51], v[228:231], v[64:79]
    ds_read_b64_tr_b16 v[32:33], v24 offset:40960
    ds_read_b64_tr_b16 v[34:35], v25 offset:43008
    v_max3_f32 v7, v7, v184, v185
    v_max3_f32 v8, v8, v186, v187
    v_max3_f32 v5, v5, v188, v189
    v_max3_f32 v6, v6, v190, v191
    v_max3_f32 v5, v5, v6, v7
    v_max_f32 v5, v5, v8
    v_mov_b32 v6, v5
    s_nop 1
    v_permlane32_swap_b32 v5, v6
    v_max_f32 v5, v5, v6
    v_mul_f32 v5, s64, v5
    v_sub_f32 v6, v5, v2
    v_cmp_lt_f32 vcc, 0x41000000, v6
    s_cbranch_vccz L_nors_L1
    v_max_f32 v7, v2, v5
    v_sub_f32 v8, v2, v7
    v_exp_f32 v4, v8
    v_mov_b32 v2, v7
    s_mov_b32 s63, 1
    v_mul_f32 v3, v3, v4
L_nors_L1:
    s_waitcnt lgkmcnt(6)
    v_mfma_f32_32x32x16_bf16 v[80:95], v[52:55], v[228:231], v[80:95]
    ds_read_b64_tr_b16 v[36:37], v26 offset:40960
    ds_read_b64_tr_b16 v[38:39], v27 offset:43008
    v_fma_f32 v160, v160, s64, -v2
    v_fma_f32 v161, v161, s64, -v2
    v_fma_f32 v162, v162, s64, -v2
    v_fma_f32 v163, v163, s64, -v2
    v_exp_f32 v160, v160
    v_exp_f32 v161, v161
    s_waitcnt lgkmcnt(6)
    v_mfma_f32_32x32x16_bf16 v[96:111], v[56:59], v[228:231], v[96:111]
    ds_read_b64_tr_b16 v[40:41], v28 offset:40960
    ds_read_b64_tr_b16 v[42:43], v29 offset:43008
    v_exp_f32 v162, v162
    v_exp_f32 v163, v163
    v_fma_f32 v164, v164, s64, -v2
    v_fma_f32 v165, v165, s64, -v2
    v_fma_f32 v166, v166, s64, -v2
    v_fma_f32 v167, v167, s64, -v2
    v_exp_f32 v164, v164
    v_exp_f32 v165, v165
    v_exp_f32 v166, v166
    s_waitcnt lgkmcnt(6)
    v_mfma_f32_32x32x16_bf16 v[112:127], v[60:63], v[228:231], v[112:127]
    ds_read_b64_tr_b16 v[44:45], v30 offset:40960
    ds_read_b64_tr_b16 v[46:47], v31 offset:43008
    v_exp_f32 v167, v167
    v_add_f32 v9, v160, v161
    v_add_f32 v10, v162, v163
    v_fma_f32 v168, v168, s64, -v2
    v_fma_f32 v169, v169, s64, -v2
    v_fma_f32 v170, v170, s64, -v2
    v_fma_f32 v171, v171, s64, -v2
    v_exp_f32 v168, v168
    v_exp_f32 v169, v169
    s_waitcnt lgkmcnt(6)
    v_mfma_f32_32x32x16_bf16 v[64:79], v[32:35], v[232:235], v[64:79]
    ds_read_b64_tr_b16 v[48:49], v24 offset:45056
    ds_read_b64_tr_b16 v[50:51], v25 offset:47104
    v_exp_f32 v170, v170
    v_exp_f32 v171, v171
    v_add_f32 v9, v9, v164
    v_add_f32 v10, v10, v165
    v_add_f32 v9, v9, v166
    v_add_f32 v10, v10, v167
    v_fma_f32 v172, v172, s64, -v2
    v_fma_f32 v173, v173, s64, -v2
    v_fma_f32 v174, v174, s64, -v2
    v_fma_f32 v175, v175, s64, -v2
    v_exp_f32 v172, v172
    s_waitcnt lgkmcnt(6)
    v_mfma_f32_32x32x16_bf16 v[80:95], v[36:39], v[232:235], v[80:95]
    ds_read_b64_tr_b16 v[52:53], v26 offset:45056
    ds_read_b64_tr_b16 v[54:55], v27 offset:47104
    v_exp_f32 v173, v173
    v_exp_f32 v174, v174
    v_exp_f32 v175, v175
    v_add_f32 v9, v9, v168
    v_add_f32 v10, v10, v169
    v_add_f32 v9, v9, v170
    v_add_f32 v10, v10, v171
    v_fma_f32 v176, v176, s64, -v2
    v_fma_f32 v177, v177, s64, -v2
    v_fma_f32 v178, v178, s64, -v2
    v_fma_f32 v179, v179, s64, -v2
    s_waitcnt lgkmcnt(6)
    v_mfma_f32_32x32x16_bf16 v[96:111], v[40:43], v[232:235], v[96:111]
    ds_read_b64_tr_b16 v[56:57], v28 offset:45056
    ds_read_b64_tr_b16 v[58:59], v29 offset:47104
    v_exp_f32 v176, v176
    v_exp_f32 v177, v177
    v_exp_f32 v178, v178
    v_exp_f32 v179, v179
    v_add_f32 v9, v9, v172
    v_add_f32 v10, v10, v173
    v_add_f32 v9, v9, v174
    v_add_f32 v10, v10, v175
    v_fma_f32 v180, v180, s64, -v2
    v_fma_f32 v181, v181, s64, -v2
    s_waitcnt lgkmcnt(6)
    v_mfma_f32_32x32x16_bf16 v[112:127], v[44:47], v[232:235], v[112:127]
    ds_read_b64_tr_b16 v[60:61], v30 offset:45056
    ds_read_b64_tr_b16 v[62:63], v31 offset:47104
    v_fma_f32 v182, v182, s64, -v2
    v_fma_f32 v183, v183, s64, -v2
    v_exp_f32 v180, v180
    v_exp_f32 v181, v181
    v_exp_f32 v182, v182
    v_exp_f32 v183, v183
    v_add_f32 v9, v9, v176
    v_add_f32 v10, v10, v177
    v_add_f32 v9, v9, v178
    v_add_f32 v10, v10, v179
    s_waitcnt lgkmcnt(6)
    v_mfma_f32_32x32x16_bf16 v[64:79], v[48:51], v[236:239], v[64:79]
    v_fma_f32 v184, v184, s64, -v2
    v_fma_f32 v185, v185, s64, -v2
    v_fma_f32 v186, v186, s64, -v2
    v_fma_f32 v187, v187, s64, -v2
    v_exp_f32 v184, v184
    v_exp_f32 v185, v185
    v_exp_f32 v186, v186
    v_exp_f32 v187, v187
    v_add_f32 v9, v9, v180
    v_add_f32 v10, v10, v181
    s_waitcnt lgkmcnt(4)
    v_mfma_f32_32x32x16_bf16 v[80:95], v[52:55], v[236:239], v[80:95]
    v_add_f32 v9, v9, v182
    v_add_f32 v10, v10, v183
    v_fma_f32 v188, v188, s64, -v2
    v_fma_f32 v189, v189, s64, -v2
    v_fma_f32 v190, v190, s64, -v2
    v_fma_f32 v191, v191, s64, -v2
    v_exp_f32 v188, v188
    v_exp_f32 v189, v189
    v_exp_f32 v190, v190
    v_exp_f32 v191, v191
    s_waitcnt lgkmcnt(2)
    v_mfma_f32_32x32x16_bf16 v[96:111], v[56:59], v[236:239], v[96:111]
    v_add_f32 v9, v9, v184
    v_add_f32 v10, v10, v185
    v_add_f32 v9, v9, v186
    v_add_f32 v10, v10, v187
    v_mov_b32 v6, v6
    v_add_f32 v9, v9, v188
    v_add_f32 v10, v10, v189
    v_add_f32 v9, v9, v190
    v_add_f32 v10, v10, v191
    v_add_f32 v9, v9, v10
    v_add_f32 v3, v3, v9
    s_waitcnt lgkmcnt(0)
    v_mfma_f32_32x32x16_bf16 v[112:127], v[60:63], v[236:239], v[112:127]
    v_cvt_pk_bf16_f32 v224, v160, v161
    v_cvt_pk_bf16_f32 v225, v162, v163
    v_cvt_pk_bf16_f32 v226, v164, v165
    v_cvt_pk_bf16_f32 v227, v166, v167
    v_cvt_pk_bf16_f32 v228, v168, v169
    v_cvt_pk_bf16_f32 v229, v170, v171
    v_cvt_pk_bf16_f32 v230, v172, v173
    v_cvt_pk_bf16_f32 v231, v174, v175
    v_cvt_pk_bf16_f32 v232, v176, v177
    v_cvt_pk_bf16_f32 v233, v178, v179
    v_cvt_pk_bf16_f32 v234, v180, v181
    v_cvt_pk_bf16_f32 v235, v182, v183
    v_cvt_pk_bf16_f32 v236, v184, v185
    v_cvt_pk_bf16_f32 v237, v186, v187
    v_cvt_pk_bf16_f32 v238, v188, v189
    v_cvt_pk_bf16_f32 v239, v190, v191
    s_branch L_E1
L_L0:
    s_waitcnt vmcnt(0)
    s_barrier
    ds_read_b64_tr_b16 v[32:33], v24 offset:49152
    ds_read_b64_tr_b16 v[34:35], v25 offset:51200
    ds_read_b64_tr_b16 v[36:37], v26 offset:49152
    ds_read_b64_tr_b16 v[38:39], v27 offset:51200
    ds_read_b64_tr_b16 v[40:41], v28 offset:49152
    ds_read_b64_tr_b16 v[42:43], v29 offset:51200
    ds_read_b64_tr_b16 v[44:45], v30 offset:49152
    ds_read_b64_tr_b16 v[46:47], v31 offset:51200
    s_cmp_eq_u32 s63, 0
    s_cbranch_scc1 L_noo_L0
    v_mul_f32 v64, v64, v4
    v_mul_f32 v65, v65, v4
    v_mul_f32 v66, v66, v4
    v_mul_f32 v67, v67, v4
    v_mul_f32 v68, v68, v4
    v_mul_f32 v69, v69, v4
    v_mul_f32 v70, v70, v4
    v_mul_f32 v71, v71, v4
    v_mul_f32 v72, v72, v4
    v_mul_f32 v73, v73, v4
    v_mul_f32 v74, v74, v4
    v_mul_f32 v75, v75, v4
    v_mul_f32 v76, v76, v4
    v_mul_f32 v77, v77, v4
    v_mul_f32 v78, v78, v4
    v_mul_f32 v79, v79, v4
    v_mul_f32 v80, v80, v4
    v_mul_f32 v81, v81, v4
    v_mul_f32 v82, v82, v4
    v_mul_f32 v83, v83, v4
    v_mul_f32 v84, v84, v4
    v_mul_f32 v85, v85, v4
    v_mul_f32 v86, v86, v4
    v_mul_f32 v87, v87, v4
    v_mul_f32 v88, v88, v4
    v_mul_f32 v89, v89, v4
    v_mul_f32 v90, v90, v4
    v_mul_f32 v91, v91, v4
    v_mul_f32 v92, v92, v4
    v_mul_f32 v93, v93, v4
    v_mul_f32 v94, v94, v4
    v_mul_f32 v95, v95, v4
    v_mul_f32 v96, v96, v4
    v_mul_f32 v97, v97, v4
    v_mul_f32 v98, v98, v4
    v_mul_f32 v99, v99, v4
    v_mul_f32 v100, v100, v4
    v_mul_f32 v101, v101, v4
    v_mul_f32 v102, v102, v4
    v_mul_f32 v103, v103, v4
    v_mul_f32 v104, v104, v4
    v_mul_f32 v105, v105, v4
    v_mul_f32 v106, v106, v4
    v_mul_f32 v107, v107, v4
    v_mul_f32 v108, v108, v4
    v_mul_f32 v109, v109, v4
    v_mul_f32 v110, v110, v4
    v_mul_f32 v111, v111, v4
    v_mul_f32 v112, v112, v4
    v_mul_f32 v113, v113, v4
    v_mul_f32 v114, v114, v4
    v_mul_f32 v115, v115, v4
    v_mul_f32 v116, v116, v4
    v_mul_f32 v117, v117, v4
    v_mul_f32 v118, v118, v4
    v_mul_f32 v119, v119, v4
    v_mul_f32 v120, v120, v4
    v_mul_f32 v121, v121, v4
    v_mul_f32 v122, v122, v4
    v_mul_f32 v123, v123, v4
    v_mul_f32 v124, v124, v4
    v_mul_f32 v125, v125, v4
    v_mul_f32 v126, v126, v4
    v_mul_f32 v127, v127, v4
    s_mov_b32 s63, 0
    s_nop 1
L_noo_L0:
    s_add_u32 m0, s65, 32768
    s_nop 0
    buffer_load_dwordx4 v12, s[24:27], s61 offen offset:0 lds
    buffer_load_dwordx4 v13, s[24:27], s61 offen offset:1024 lds
    buffer_load_dwordx4 v14, s[24:27], s61 offen offset:2048 lds
    buffer_load_dwordx4 v15, s[24:27], s61 offen offset:3072 lds
    s_add_u32 s61, s61, 131072
    v_mov_b32 v10, 0xff800000
    v_cmp_gt_i32 s[70:71], 0, v240
    v_cmp_gt_i32 s[72:73], 1, v240
    v_cmp_gt_i32 s[74:75], 2, v240
    v_cmp_gt_i32 s[76:77], 3, v240
    v_cndmask_b32 v128, v128, v10, s[70:71]
    v_cndmask_b32 v129, v129, v10, s[72:73]
    v_cndmask_b32 v130, v130, v10, s[74:75]
    v_cndmask_b32 v131, v131, v10, s[76:77]
    v_cmp_gt_i32 s[70:71], 8, v240
    v_cmp_gt_i32 s[72:73], 9, v240
    v_cmp_gt_i32 s[74:75], 10, v240
    v_cmp_gt_i32 s[76:77], 11, v240
    v_cndmask_b32 v132, v132, v10, s[70:71]
    v_cndmask_b32 v133, v133, v10, s[72:73]
    v_cndmask_b32 v134, v134, v10, s[74:75]
    v_cndmask_b32 v135, v135, v10, s[76:77]
    v_cmp_gt_i32 s[70:71], 16, v240
    v_cmp_gt_i32 s[72:73], 17, v240
    v_cmp_gt_i32 s[74:75], 18, v240
    v_cmp_gt_i32 s[76:77], 19, v240
    v_cndmask_b32 v136, v136, v10, s[70:71]
    v_cndmask_b32 v137, v137, v10, s[72:73]
    v_cndmask_b32 v138, v138, v10, s[74:75]
    v_cndmask_b32 v139, v139, v10, s[76:77]
    s_waitcnt lgkmcnt(6)
    v_mfma_f32_32x32x16_bf16 v[64:79], v[32:35], v[224:227], v[64:79]
    ds_read_b64_tr_b16 v[48:49], v24 offset:53248
    ds_read_b64_tr_b16 v[50:51], v25 offset:55296
    v_cmp_gt_i32 s[70:71], 24, v240
    v_cmp_gt_i32 s[72:73], 25, v240
    v_cmp_gt_i32 s[74:75], 26, v240
    v_cmp_gt_i32 s[76:77], 27, v240
    v_cndmask_b32 v140, v140, v10, s[70:71]
    v_cndmask_b32 v141, v141, v10, s[72:73]
    v_cndmask_b32 v142, v142, v10, s[74:75]
    v_cndmask_b32 v143, v143, v10, s[76:77]
    s_waitcnt lgkmcnt(6)
    v_mfma_f32_32x32x16_bf16 v[80:95], v[36:39], v[224:227], v[80:95]
    ds_read_b64_tr_b16 v[52:53], v26 offset:53248
    ds_read_b64_tr_b16 v[54:55], v27 offset:55296
    v_cmp_gt_i32 s[70:71], 32, v240
    v_cmp_gt_i32 s[72:73], 33, v240
    v_cmp_gt_i32 s[74:75], 34, v240
    v_cmp_gt_i32 s[76:77], 35, v240
    v_cndmask_b32 v144, v144, v10, s[70:71]
    v_cndmask_b32 v145, v145, v10, s[72:73]
    v_cndmask_b32 v146, v146, v10, s[74:75]
    v_cndmask_b32 v147, v147, v10, s[76:77]
    v_cmp_gt_i32 s[70:71], 40, v240
    v_cmp_gt_i32 s[72:73], 41, v240
    v_cmp_gt_i32 s[74:75], 42, v240
    v_cmp_gt_i32 s[76:77], 43, v240
    v_cndmask_b32 v148, v148, v10, s[70:71]
    v_cndmask_b32 v149, v149, v10, s[72:73]
    v_cndmask_b32 v150, v150, v10, s[74:75]
    v_cndmask_b32 v151, v151, v10, s[76:77]
    s_waitcnt lgkmcnt(6)
    v_mfma_f32_32x32x16_bf16 v[96:111], v[40:43], v[224:227], v[96:111]
    ds_read_b64_tr_b16 v[56:57], v28 offset:53248
    ds_read_b64_tr_b16 v[58:59], v29 offset:55296
    v_cmp_gt_i32 s[70:71], 48, v240
    v_cmp_gt_i32 s[72:73], 49, v240
    v_cmp_gt_i32 s[74:75], 50, v240
    v_cmp_gt_i32 s[76:77], 51, v240
    v_cndmask_b32 v152, v152, v10, s[70:71]
    v_cndmask_b32 v153, v153, v10, s[72:73]
    v_cndmask_b32 v154, v154, v10, s[74:75]
    v_cndmask_b32 v155, v155, v10, s[76:77]
    v_cmp_gt_i32 s[70:71], 56, v240
    v_cmp_gt_i32 s[72:73], 57, v240
    v_cmp_gt_i32 s[74:75], 58, v240
    v_cmp_gt_i32 s[76:77], 59, v240
    v_cndmask_b32 v156, v156, v10, s[70:71]
    v_cndmask_b32 v157, v157, v10, s[72:73]
    v_cndmask_b32 v158, v158, v10, s[74:75]
    v_cndmask_b32 v159, v159, v10, s[76:77]
    s_waitcnt lgkmcnt(6)
    v_mfma_f32_32x32x16_bf16 v[112:127], v[44:47], v[224:227], v[112:127]
    ds_read_b64_tr_b16 v[60:61], v30 offset:53248
    ds_read_b64_tr_b16 v[62:63], v31 offset:55296
    v_max3_f32 v5, v128, v129, v130
    v_max3_f32 v6, v131, v132, v133
    v_max3_f32 v7, v134, v135, v136
    v_max3_f32 v8, v137, v138, v139
    v_max3_f32 v5, v5, v140, v141
    v_max3_f32 v6, v6, v142, v143
    v_max3_f32 v7, v7, v144, v145
    v_max3_f32 v8, v8, v146, v147
    v_max3_f32 v5, v5, v148, v149
    v_max3_f32 v6, v6, v150, v151
    s_waitcnt lgkmcnt(6)
    v_mfma_f32_32x32x16_bf16 v[64:79], v[48:51], v[228:231], v[64:79]
    ds_read_b64_tr_b16 v[32:33], v24 offset:57344
    ds_read_b64_tr_b16 v[34:35], v25 offset:59392
    v_max3_f32 v7, v7, v152, v153
    v_max3_f32 v8, v8, v154, v155
    v_max3_f32 v5, v5, v156, v157
    v_max3_f32 v6, v6, v158, v159
    v_max3_f32 v5, v5, v6, v7
    v_max_f32 v5, v5, v8
    v_mov_b32 v6, v5
    s_nop 1
    v_permlane32_swap_b32 v5, v6
    v_max_f32 v5, v5, v6
    v_mul_f32 v5, s64, v5
    v_sub_f32 v6, v5, v2
    v_cmp_lt_f32 vcc, 0x41000000, v6
    s_cbranch_vccz L_nors_L0
    v_max_f32 v7, v2, v5
    v_sub_f32 v8, v2, v7
    v_exp_f32 v4, v8
    v_mov_b32 v2, v7
    s_mov_b32 s63, 1
    v_mul_f32 v3, v3, v4
L_nors_L0:
    s_waitcnt lgkmcnt(6)
    v_mfma_f32_32x32x16_bf16 v[80:95], v[52:55], v[228:231], v[80:95]
    ds_read_b64_tr_b16 v[36:37], v26 offset:57344
    ds_read_b64_tr_b16 v[38:39], v27 offset:59392
    v_fma_f32 v128, v128, s64, -v2
    v_fma_f32 v129, v129, s64, -v2
    v_fma_f32 v130, v130, s64, -v2
    v_fma_f32 v131, v131, s64, -v2
    v_exp_f32 v128, v128
    v_exp_f32 v129, v129
    s_waitcnt lgkmcnt(6)
    v_mfma_f32_32x32x16_bf16 v[96:111], v[56:59], v[228:231], v[96:111]
    ds_read_b64_tr_b16 v[40:41], v28 offset:57344
    ds_read_b64_tr_b16 v[42:43], v29 offset:59392
    v_exp_f32 v130, v130
    v_exp_f32 v131, v131
    v_fma_f32 v132, v132, s64, -v2
    v_fma_f32 v133, v133, s64, -v2
    v_fma_f32 v134, v134, s64, -v2
    v_fma_f32 v135, v135, s64, -v2
    v_exp_f32 v132, v132
    v_exp_f32 v133, v133
    v_exp_f32 v134, v134
    s_waitcnt lgkmcnt(6)
    v_mfma_f32_32x32x16_bf16 v[112:127], v[60:63], v[228:231], v[112:127]
    ds_read_b64_tr_b16 v[44:45], v30 offset:57344
    ds_read_b64_tr_b16 v[46:47], v31 offset:59392
    v_exp_f32 v135, v135
    v_add_f32 v9, v128, v129
    v_add_f32 v10, v130, v131
    v_fma_f32 v136, v136, s64, -v2
    v_fma_f32 v137, v137, s64, -v2
    v_fma_f32 v138, v138, s64, -v2
    v_fma_f32 v139, v139, s64, -v2
    v_exp_f32 v136, v136
    v_exp_f32 v137, v137
    s_waitcnt lgkmcnt(6)
    v_mfma_f32_32x32x16_bf16 v[64:79], v[32:35], v[232:235], v[64:79]
    ds_read_b64_tr_b16 v[48:49], v24 offset:61440
    ds_read_b64_tr_b16 v[50:51], v25 offset:63488
    v_exp_f32 v138, v138
    v_exp_f32 v139, v139
    v_add_f32 v9, v9, v132
    v_add_f32 v10, v10, v133
    v_add_f32 v9, v9, v134
    v_add_f32 v10, v10, v135
    v_fma_f32 v140, v140, s64, -v2
    v_fma_f32 v141, v141, s64, -v2
    v_fma_f32 v142, v142, s64, -v2
    v_fma_f32 v143, v143, s64, -v2
    v_exp_f32 v140, v140
    s_waitcnt lgkmcnt(6)
    v_mfma_f32_32x32x16_bf16 v[80:95], v[36:39], v[232:235], v[80:95]
    ds_read_b64_tr_b16 v[52:53], v26 offset:61440
    ds_read_b64_tr_b16 v[54:55], v27 offset:63488
    v_exp_f32 v141, v141
    v_exp_f32 v142, v142
    v_exp_f32 v143, v143
    v_add_f32 v9, v9, v136
    v_add_f32 v10, v10, v137
    v_add_f32 v9, v9, v138
    v_add_f32 v10, v10, v139
    v_fma_f32 v144, v144, s64, -v2
    v_fma_f32 v145, v145, s64, -v2
    v_fma_f32 v146, v146, s64, -v2
    v_fma_f32 v147, v147, s64, -v2
    s_waitcnt lgkmcnt(6)
    v_mfma_f32_32x32x16_bf16 v[96:111], v[40:43], v[232:235], v[96:111]
    ds_read_b64_tr_b16 v[56:57], v28 offset:61440
    ds_read_b64_tr_b16 v[58:59], v29 offset:63488
    v_exp_f32 v144, v144
    v_exp_f32 v145, v145
    v_exp_f32 v146, v146
    v_exp_f32 v147, v147
    v_add_f32 v9, v9, v140
    v_add_f32 v10, v10, v141
    v_add_f32 v9, v9, v142
    v_add_f32 v10, v10, v143
    v_fma_f32 v148, v148, s64, -v2
    v_fma_f32 v149, v149, s64, -v2
    s_waitcnt lgkmcnt(6)
    v_mfma_f32_32x32x16_bf16 v[112:127], v[44:47], v[232:235], v[112:127]
    ds_read_b64_tr_b16 v[60:61], v30 offset:61440
    ds_read_b64_tr_b16 v[62:63], v31 offset:63488
    v_fma_f32 v150, v150, s64, -v2
    v_fma_f32 v151, v151, s64, -v2
    v_exp_f32 v148, v148
    v_exp_f32 v149, v149
    v_exp_f32 v150, v150
    v_exp_f32 v151, v151
    v_add_f32 v9, v9, v144
    v_add_f32 v10, v10, v145
    v_add_f32 v9, v9, v146
    v_add_f32 v10, v10, v147
    s_waitcnt lgkmcnt(6)
    v_mfma_f32_32x32x16_bf16 v[64:79], v[48:51], v[236:239], v[64:79]
    v_fma_f32 v152, v152, s64, -v2
    v_fma_f32 v153, v153, s64, -v2
    v_fma_f32 v154, v154, s64, -v2
    v_fma_f32 v155, v155, s64, -v2
    v_exp_f32 v152, v152
    v_exp_f32 v153, v153
    v_exp_f32 v154, v154
    v_exp_f32 v155, v155
    v_add_f32 v9, v9, v148
    v_add_f32 v10, v10, v149
    s_waitcnt lgkmcnt(4)
    v_mfma_f32_32x32x16_bf16 v[80:95], v[52:55], v[236:239], v[80:95]
    v_add_f32 v9, v9, v150
    v_add_f32 v10, v10, v151
    v_fma_f32 v156, v156, s64, -v2
    v_fma_f32 v157, v157, s64, -v2
    v_fma_f32 v158, v158, s64, -v2
    v_fma_f32 v159, v159, s64, -v2
    v_exp_f32 v156, v156
    v_exp_f32 v157, v157
    v_exp_f32 v158, v158
    v_exp_f32 v159, v159
    s_waitcnt lgkmcnt(2)
    v_mfma_f32_32x32x16_bf16 v[96:111], v[56:59], v[236:239], v[96:111]
    v_add_f32 v9, v9, v152
    v_add_f32 v10, v10, v153
    v_add_f32 v9, v9, v154
    v_add_f32 v10, v10, v155
    v_mov_b32 v6, v6
    v_add_f32 v9, v9, v156
    v_add_f32 v10, v10, v157
    v_add_f32 v9, v9, v158
    v_add_f32 v10, v10, v159
    v_add_f32 v9, v9, v10
    v_add_f32 v3, v3, v9
    s_waitcnt lgkmcnt(0)
    v_mfma_f32_32x32x16_bf16 v[112:127], v[60:63], v[236:239], v[112:127]
    v_cvt_pk_bf16_f32 v224, v128, v129
    v_cvt_pk_bf16_f32 v225, v130, v131
    v_cvt_pk_bf16_f32 v226, v132, v133
    v_cvt_pk_bf16_f32 v227, v134, v135
    v_cvt_pk_bf16_f32 v228, v136, v137
    v_cvt_pk_bf16_f32 v229, v138, v139
    v_cvt_pk_bf16_f32 v230, v140, v141
    v_cvt_pk_bf16_f32 v231, v142, v143
    v_cvt_pk_bf16_f32 v232, v144, v145
    v_cvt_pk_bf16_f32 v233, v146, v147
    v_cvt_pk_bf16_f32 v234, v148, v149
    v_cvt_pk_bf16_f32 v235, v150, v151
    v_cvt_pk_bf16_f32 v236, v152, v153
    v_cvt_pk_bf16_f32 v237, v154, v155
    v_cvt_pk_bf16_f32 v238, v156, v157
    v_cvt_pk_bf16_f32 v239, v158, v159
    s_branch L_E0
L_S0:
    s_waitcnt vmcnt(0)
    s_barrier
    s_add_u32 m0, s65, 32768
    s_nop 0
    buffer_load_dwordx4 v12, s[24:27], s61 offen offset:0 lds
    buffer_load_dwordx4 v13, s[24:27], s61 offen offset:1024 lds
    buffer_load_dwordx4 v14, s[24:27], s61 offen offset:2048 lds
    buffer_load_dwordx4 v15, s[24:27], s61 offen offset:3072 lds
    s_add_u32 s61, s61, 131072
    v_mov_b32 v10, 0xff800000
    v_cmp_gt_i32 s[70:71], 0, v240
    v_cmp_gt_i32 s[72:73], 1, v240
    v_cmp_gt_i32 s[74:75], 2, v240
    v_cmp_gt_i32 s[76:77], 3, v240
    v_cndmask_b32 v128, v128, v10, s[70:71]
    v_cndmask_b32 v129, v129, v10, s[72:73]
    v_cndmask_b32 v130, v130, v10, s[74:75]
    v_cndmask_b32 v131, v131, v10, s[76:77]
    v_cmp_gt_i32 s[70:71], 8, v240
    v_cmp_gt_i32 s[72:73], 9, v240
    v_cmp_gt_i32 s[74:75], 10, v240
    v_cmp_gt_i32 s[76:77], 11, v240
    v_cndmask_b32 v132, v132, v10, s[70:71]
    v_cndmask_b32 v133, v133, v10, s[72:73]
    v_cndmask_b32 v134, v134, v10, s[74:75]
    v_cndmask_b32 v135, v135, v10, s[76:77]
    v_cmp_gt_i32 s[70:71], 16, v240
    v_cmp_gt_i32 s[72:73], 17, v240
    v_cmp_gt_i32 s[74:75], 18, v240
    v_cmp_gt_i32 s[76:77], 19, v240
    v_cndmask_b32 v136, v136, v10, s[70:71]
    v_cndmask_b32 v137, v137, v10, s[72:73]
    v_cndmask_b32 v138, v138, v10, s[74:75]
    v_cndmask_b32 v139, v139, v10, s[76:77]
    v_cmp_gt_i32 s[70:71], 24, v240
    v_cmp_gt_i32 s[72:73], 25, v240
    v_cmp_gt_i32 s[74:75], 26, v240
    v_cmp_gt_i32 s[76:77], 27, v240
    v_cndmask_b32 v140, v140, v10, s[70:71]
    v_cndmask_b32 v141, v141, v10, s[72:73]
    v_cndmask_b32 v142, v142, v10, s[74:75]
    v_cndmask_b32 v143, v143, v10, s[76:77]
    v_cmp_gt_i32 s[70:71], 32, v240
    v_cmp_gt_i32 s[72:73], 33, v240
    v_cmp_gt_i32 s[74:75], 34, v240
    v_cmp_gt_i32 s[76:77], 35, v240
    v_cndmask_b32 v144, v144, v10, s[70:71]
    v_cndmask_b32 v145, v145, v10, s[72:73]
    v_cndmask_b32 v146, v146, v10, s[74:75]
    v_cndmask_b32 v147, v147, v10, s[76:77]
    v_cmp_gt_i32 s[70:71], 40, v240
    v_cmp_gt_i32 s[72:73], 41, v240
    v_cmp_gt_i32 s[74:75], 42, v240
    v_cmp_gt_i32 s[76:77], 43, v240
    v_cndmask_b32 v148, v148, v10, s[70:71]
    v_cndmask_b32 v149, v149, v10, s[72:73]
    v_cndmask_b32 v150, v150, v10, s[74:75]
    v_cndmask_b32 v151, v151, v10, s[76:77]
    v_cmp_gt_i32 s[70:71], 48, v240
    v_cmp_gt_i32 s[72:73], 49, v240
    v_cmp_gt_i32 s[74:75], 50, v240
    v_cmp_gt_i32 s[76:77], 51, v240
    v_cndmask_b32 v152, v152, v10, s[70:71]
    v_cndmask_b32 v153, v153, v10, s[72:73]
    v_cndmask_b32 v154, v154, v10, s[74:75]
    v_cndmask_b32 v155, v155, v10, s[76:77]
    v_cmp_gt_i32 s[70:71], 56, v240
    v_cmp_gt_i32 s[72:73], 57, v240
    v_cmp_gt_i32 s[74:75], 58, v240
    v_cmp_gt_i32 s[76:77], 59, v240
    v_cndmask_b32 v156, v156, v10, s[70:71]
    v_cndmask_b32 v157, v157, v10, s[72:73]
    v_cndmask_b32 v158, v158, v10, s[74:75]
    v_cndmask_b32 v159, v159, v10, s[76:77]
    v_max3_f32 v5, v128, v129, v130
    v_max3_f32 v6, v131, v132, v133
    v_max3_f32 v7, v134, v135, v136
    v_max3_f32 v8, v137, v138, v139
    v_max3_f32 v5, v5, v140, v141
    v_max3_f32 v6, v6, v142, v143
    v_max3_f32 v7, v7, v144, v145
    v_max3_f32 v8, v8, v146, v147
    v_max3_f32 v5, v5, v148, v149
    v_max3_f32 v6, v6, v150, v151
    v_max3_f32 v7, v7, v152, v153
    v_max3_f32 v8, v8, v154, v155
    v_max3_f32 v5, v5, v156, v157
    v_max3_f32 v6, v6, v158, v159
    v_max3_f32 v5, v5, v6, v7
    v_max_f32 v5, v5, v8
    v_mov_b32 v6, v5
    s_nop 1
    v_permlane32_swap_b32 v5, v6
    v_max_f32 v5, v5, v6
    v_mul_f32 v5, s64, v5
    v_mov_b32 v2, v5
    v_fma_f32 v128, v128, s64, -v2
    v_fma_f32 v129, v129, s64, -v2
    v_fma_f32 v130, v130, s64, -v2
    v_fma_f32 v131, v131, s64, -v2
    v_exp_f32 v128, v128
    v_exp_f32 v129, v129
    v_exp_f32 v130, v130
    v_exp_f32 v131, v131
    v_fma_f32 v132, v132, s64, -v2
    v_fma_f32 v133, v133, s64, -v2
    v_fma_f32 v134, v134, s64, -v2
    v_fma_f32 v135, v135, s64, -v2
    v_exp_f32 v132, v132
    v_exp_f32 v133, v133
    v_exp_f32 v134, v134
    v_exp_f32 v135, v135
    v_add_f32 v9, v128, v129
    v_add_f32 v10, v130, v131
    v_fma_f32 v136, v136, s64, -v2
    v_fma_f32 v137, v137, s64, -v2
    v_fma_f32 v138, v138, s64, -v2
    v_fma_f32 v139, v139, s64, -v2
    v_exp_f32 v136, v136
    v_exp_f32 v137, v137
    v_exp_f32 v138, v138
    v_exp_f32 v139, v139
    v_add_f32 v9, v9, v132
    v_add_f32 v10, v10, v133
    v_add_f32 v9, v9, v134
    v_add_f32 v10, v10, v135
    v_fma_f32 v140, v140, s64, -v2
    v_fma_f32 v141, v141, s64, -v2
    v_fma_f32 v142, v142, s64, -v2
    v_fma_f32 v143, v143, s64, -v2
    v_exp_f32 v140, v140
    v_exp_f32 v141, v141
    v_exp_f32 v142, v142
    v_exp_f32 v143, v143
    v_add_f32 v9, v9, v136
    v_add_f32 v10, v10, v137
    v_add_f32 v9, v9, v138
    v_add_f32 v10, v10, v139
    v_fma_f32 v144, v144, s64, -v2
    v_fma_f32 v145, v145, s64, -v2
    v_fma_f32 v146, v146, s64, -v2
    v_fma_f32 v147, v147, s64, -v2
    v_exp_f32 v144, v144
    v_exp_f32 v145, v145
    v_exp_f32 v146, v146
    v_exp_f32 v147, v147
    v_add_f32 v9, v9, v140
    v_add_f32 v10, v10, v141
    v_add_f32 v9, v9, v142
    v_add_f32 v10, v10, v143
    v_fma_f32 v148, v148, s64, -v2
    v_fma_f32 v149, v149, s64, -v2
    v_fma_f32 v150, v150, s64, -v2
    v_fma_f32 v151, v151, s64, -v2
    v_exp_f32 v148, v148
    v_exp_f32 v149, v149
    v_exp_f32 v150, v150
    v_exp_f32 v151, v151
    v_add_f32 v9, v9, v144
    v_add_f32 v10, v10, v145
    v_add_f32 v9, v9, v146
    v_add_f32 v10, v10, v147
    v_fma_f32 v152, v152, s64, -v2
    v_fma_f32 v153, v153, s64, -v2
    v_fma_f32 v154, v154, s64, -v2
    v_fma_f32 v155, v155, s64, -v2
    v_exp_f32 v152, v152
    v_exp_f32 v153, v153
    v_exp_f32 v154, v154
    v_exp_f32 v155, v155
    v_add_f32 v9, v9, v148
    v_add_f32 v10, v10, v149
    v_add_f32 v9, v9, v150
    v_add_f32 v10, v10, v151
    v_fma_f32 v156, v156, s64, -v2
    v_fma_f32 v157, v157, s64, -v2
    v_fma_f32 v158, v158, s64, -v2
    v_fma_f32 v159, v159, s64, -v2
    v_exp_f32 v156, v156
    v_exp_f32 v157, v157
    v_exp_f32 v158, v158
    v_exp_f32 v159, v159
    v_add_f32 v9, v9, v152
    v_add_f32 v10, v10, v153
    v_add_f32 v9, v9, v154
    v_add_f32 v10, v10, v155
    v_mov_b32 v6, v6
    v_add_f32 v9, v9, v156
    v_add_f32 v10, v10, v157
    v_add_f32 v9, v9, v158
    v_add_f32 v10, v10, v159
    v_add_f32 v9, v9, v10
    v_add_f32 v3, v3, v9
    v_cvt_pk_bf16_f32 v224, v128, v129
    v_cvt_pk_bf16_f32 v225, v130, v131
    v_cvt_pk_bf16_f32 v226, v132, v133
    v_cvt_pk_bf16_f32 v227, v134, v135
    v_cvt_pk_bf16_f32 v228, v136, v137
    v_cvt_pk_bf16_f32 v229, v138, v139
    v_cvt_pk_bf16_f32 v230, v140, v141
    v_cvt_pk_bf16_f32 v231, v142, v143
    v_cvt_pk_bf16_f32 v232, v144, v145
    v_cvt_pk_bf16_f32 v233, v146, v147
    v_cvt_pk_bf16_f32 v234, v148, v149
    v_cvt_pk_bf16_f32 v235, v150, v151
    v_cvt_pk_bf16_f32 v236, v152, v153
    v_cvt_pk_bf16_f32 v237, v154, v155
    v_cvt_pk_bf16_f32 v238, v156, v157
    v_cvt_pk_bf16_f32 v239, v158, v159
L_E0:
    s_waitcnt vmcnt(0)
    s_barrier
    s_cmp_eq_u32 s63, 0
    s_cbranch_scc1 L_noo_E0
    v_mul_f32 v64, v64, v4
    v_mul_f32 v65, v65, v4
    v_mul_f32 v66, v66, v4
    v_mul_f32 v67, v67, v4
    v_mul_f32 v68, v68, v4
    v_mul_f32 v69, v69, v4
    v_mul_f32 v70, v70, v4
    v_mul_f32 v71, v71, v4
    v_mul_f32 v72, v72, v4
    v_mul_f32 v73, v73, v4
    v_mul_f32 v74, v74, v4
    v_mul_f32 v75, v75, v4
    v_mul_f32 v76, v76, v4
    v_mul_f32 v77, v77, v4
    v_mul_f32 v78, v78, v4
    v_mul_f32 v79, v79, v4
    v_mul_f32 v80, v80, v4
    v_mul_f32 v81, v81, v4
    v_mul_f32 v82, v82, v4
    v_mul_f32 v83, v83, v4
    v_mul_f32 v84, v84, v4
    v_mul_f32 v85, v85, v4
    v_mul_f32 v86, v86, v4
    v_mul_f32 v87, v87, v4
    v_mul_f32 v88, v88, v4
    v_mul_f32 v89, v89, v4
    v_mul_f32 v90, v90, v4
    v_mul_f32 v91, v91, v4
    v_mul_f32 v92, v92, v4
    v_mul_f32 v93, v93, v4
    v_mul_f32 v94, v94, v4
    v_mul_f32 v95, v95, v4
    v_mul_f32 v96, v96, v4
    v_mul_f32 v97, v97, v4
    v_mul_f32 v98, v98, v4
    v_mul_f32 v99, v99, v4
    v_mul_f32 v100, v100, v4
    v_mul_f32 v101, v101, v4
    v_mul_f32 v102, v102, v4
    v_mul_f32 v103, v103, v4
    v_mul_f32 v104, v104, v4
    v_mul_f32 v105, v105, v4
    v_mul_f32 v106, v106, v4
    v_mul_f32 v107, v107, v4
    v_mul_f32 v108, v108, v4
    v_mul_f32 v109, v109, v4
    v_mul_f32 v110, v110, v4
    v_mul_f32 v111, v111, v4
    v_mul_f32 v112, v112, v4
    v_mul_f32 v113, v113, v4
    v_mul_f32 v114, v114, v4
    v_mul_f32 v115, v115, v4
    v_mul_f32 v116, v116, v4
    v_mul_f32 v117, v117, v4
    v_mul_f32 v118, v118, v4
    v_mul_f32 v119, v119, v4
    v_mul_f32 v120, v120, v4
    v_mul_f32 v121, v121, v4
    v_mul_f32 v122, v122, v4
    v_mul_f32 v123, v123, v4
    v_mul_f32 v124, v124, v4
    v_mul_f32 v125, v125, v4
    v_mul_f32 v126, v126, v4
    v_mul_f32 v127, v127, v4
    s_mov_b32 s63, 0
    s_nop 1
L_noo_E0:
    ds_read_b64_tr_b16 v[32:33], v24 offset:32768
    ds_read_b64_tr_b16 v[34:35], v25 offset:34816
    ds_read_b64_tr_b16 v[36:37], v26 offset:32768
    ds_read_b64_tr_b16 v[38:39], v27 offset:34816
    ds_read_b64_tr_b16 v[40:41], v28 offset:32768
    ds_read_b64_tr_b16 v[42:43], v29 offset:34816
    ds_read_b64_tr_b16 v[44:45], v30 offset:32768
    ds_read_b64_tr_b16 v[46:47], v31 offset:34816
    v_mov_b32 v6, v3
    s_nop 1
    v_permlane32_swap_b32 v3, v6
    v_add_f32 v3, v3, v6
    v_rcp_f32 v7, v3
    v_and_b32 v5, 31, v1
    s_waitcnt lgkmcnt(6)
    v_mfma_f32_32x32x16_bf16 v[64:79], v[32:35], v[224:227], v[64:79]
    ds_read_b64_tr_b16 v[48:49], v24 offset:36864
    ds_read_b64_tr_b16 v[50:51], v25 offset:38912
    v_cmp_gt_i32 vcc, s78, v5
    s_waitcnt lgkmcnt(6)
    v_mfma_f32_32x32x16_bf16 v[80:95], v[36:39], v[224:227], v[80:95]
    ds_read_b64_tr_b16 v[52:53], v26 offset:36864
    ds_read_b64_tr_b16 v[54:55], v27 offset:38912
    s_waitcnt lgkmcnt(6)
    v_mfma_f32_32x32x16_bf16 v[96:111], v[40:43], v[224:227], v[96:111]
    ds_read_b64_tr_b16 v[56:57], v28 offset:36864
    ds_read_b64_tr_b16 v[58:59], v29 offset:38912
    s_waitcnt lgkmcnt(6)
    v_mfma_f32_32x32x16_bf16 v[112:127], v[44:47], v[224:227], v[112:127]
    ds_read_b64_tr_b16 v[60:61], v30 offset:36864
    ds_read_b64_tr_b16 v[62:63], v31 offset:38912
    s_waitcnt lgkmcnt(6)
    v_mfma_f32_32x32x16_bf16 v[64:79], v[48:51], v[228:231], v[64:79]
    ds_read_b64_tr_b16 v[32:33], v24 offset:40960
    ds_read_b64_tr_b16 v[34:35], v25 offset:43008
    v_mov_b32 v6, 0x7f000000
    s_waitcnt lgkmcnt(6)
    v_mfma_f32_32x32x16_bf16 v[80:95], v[52:55], v[228:231], v[80:95]
    ds_read_b64_tr_b16 v[36:37], v26 offset:40960
    ds_read_b64_tr_b16 v[38:39], v27 offset:43008
    s_waitcnt lgkmcnt(6)
    v_mfma_f32_32x32x16_bf16 v[96:111], v[56:59], v[228:231], v[96:111]
    ds_read_b64_tr_b16 v[40:41], v28 offset:40960
    ds_read_b64_tr_b16 v[42:43], v29 offset:43008
    s_waitcnt lgkmcnt(6)
    v_mfma_f32_32x32x16_bf16 v[112:127], v[60:63], v[228:231], v[112:127]
    ds_read_b64_tr_b16 v[44:45], v30 offset:40960
    ds_read_b64_tr_b16 v[46:47], v31 offset:43008
    s_waitcnt lgkmcnt(6)
    v_mfma_f32_32x32x16_bf16 v[64:79], v[32:35], v[232:235], v[64:79]
    ds_read_b64_tr_b16 v[48:49], v24 offset:45056
    ds_read_b64_tr_b16 v[50:51], v25 offset:47104
    s_nop 1
    s_waitcnt lgkmcnt(6)
    v_mfma_f32_32x32x16_bf16 v[80:95], v[36:39], v[232:235], v[80:95]
    ds_read_b64_tr_b16 v[52:53], v26 offset:45056
    ds_read_b64_tr_b16 v[54:55], v27 offset:47104
    s_waitcnt lgkmcnt(6)
    v_mfma_f32_32x32x16_bf16 v[96:111], v[40:43], v[232:235], v[96:111]
    ds_read_b64_tr_b16 v[56:57], v28 offset:45056
    ds_read_b64_tr_b16 v[58:59], v29 offset:47104
    s_waitcnt lgkmcnt(6)
    v_mfma_f32_32x32x16_bf16 v[112:127], v[44:47], v[232:235], v[112:127]
    ds_read_b64_tr_b16 v[60:61], v30 offset:45056
    ds_read_b64_tr_b16 v[62:63], v31 offset:47104
    s_waitcnt lgkmcnt(6)
    v_mfma_f32_32x32x16_bf16 v[64:79], v[48:51], v[236:239], v[64:79]
    v_cndmask_b32 v11, v6, v11, vcc
    s_waitcnt lgkmcnt(4)
    v_mfma_f32_32x32x16_bf16 v[80:95], v[52:55], v[236:239], v[80:95]
    s_waitcnt lgkmcnt(2)
    v_mfma_f32_32x32x16_bf16 v[96:111], v[56:59], v[236:239], v[96:111]
    s_waitcnt lgkmcnt(0)
    v_mfma_f32_32x32x16_bf16 v[112:127], v[60:63], v[236:239], v[112:127]
    s_nop 15
    v_mul_f32 v64, v64, v7
    v_mul_f32 v65, v65, v7
    v_mul_f32 v66, v66, v7
    v_mul_f32 v67, v67, v7
    v_mul_f32 v68, v68, v7
    v_mul_f32 v69, v69, v7
    v_mul_f32 v70, v70, v7
    v_mul_f32 v71, v71, v7
    v_cvt_pk_bf16_f32 v224, v64, v65
    v_cvt_pk_bf16_f32 v225, v66, v67
    v_cvt_pk_bf16_f32 v226, v68, v69
    v_cvt_pk_bf16_f32 v227, v70, v71
    s_nop 1
    v_permlane32_swap_b32 v224, v226
    v_permlane32_swap_b32 v225, v227
    buffer_store_dwordx4 v[224:227], v11, s[28:31], 0 offen offset:0
    v_mul_f32 v72, v72, v7
    v_mul_f32 v73, v73, v7
    v_mul_f32 v74, v74, v7
    v_mul_f32 v75, v75, v7
    v_mul_f32 v76, v76, v7
    v_mul_f32 v77, v77, v7
    v_mul_f32 v78, v78, v7
    v_mul_f32 v79, v79, v7
    v_cvt_pk_bf16_f32 v228, v72, v73
    v_cvt_pk_bf16_f32 v229, v74, v75
    v_cvt_pk_bf16_f32 v230, v76, v77
    v_cvt_pk_bf16_f32 v231, v78, v79
    s_nop 1
    v_permlane32_swap_b32 v228, v230
    v_permlane32_swap_b32 v229, v231
    buffer_store_dwordx4 v[228:231], v11, s[28:31], 0 offen offset:32
    v_mul_f32 v80, v80, v7
    v_mul_f32 v81, v81, v7
    v_mul_f32 v82, v82, v7
    v_mul_f32 v83, v83, v7
    v_mul_f32 v84, v84, v7
    v_mul_f32 v85, v85, v7
    v_mul_f32 v86, v86, v7
    v_mul_f32 v87, v87, v7
    v_cvt_pk_bf16_f32 v232, v80, v81
    v_cvt_pk_bf16_f32 v233, v82, v83
    v_cvt_pk_bf16_f32 v234, v84, v85
    v_cvt_pk_bf16_f32 v235, v86, v87
    s_nop 1
    v_permlane32_swap_b32 v232, v234
    v_permlane32_swap_b32 v233, v235
    buffer_store_dwordx4 v[232:235], v11, s[28:31], 0 offen offset:64
    v_mul_f32 v88, v88, v7
    v_mul_f32 v89, v89, v7
    v_mul_f32 v90, v90, v7
    v_mul_f32 v91, v91, v7
    v_mul_f32 v92, v92, v7
    v_mul_f32 v93, v93, v7
    v_mul_f32 v94, v94, v7
    v_mul_f32 v95, v95, v7
    v_cvt_pk_bf16_f32 v236, v88, v89
    v_cvt_pk_bf16_f32 v237, v90, v91
    v_cvt_pk_bf16_f32 v238, v92, v93
    v_cvt_pk_bf16_f32 v239, v94, v95
    s_nop 1
    v_permlane32_swap_b32 v236, v238
    v_permlane32_swap_b32 v237, v239
    buffer_store_dwordx4 v[236:239], v11, s[28:31], 0 offen offset:96
    v_mul_f32 v96, v96, v7
    v_mul_f32 v97, v97, v7
    v_mul_f32 v98, v98, v7
    v_mul_f32 v99, v99, v7
    v_mul_f32 v100, v100, v7
    v_mul_f32 v101, v101, v7
    v_mul_f32 v102, v102, v7
    v_mul_f32 v103, v103, v7
    v_cvt_pk_bf16_f32 v224, v96, v97
    v_cvt_pk_bf16_f32 v225, v98, v99
    v_cvt_pk_bf16_f32 v226, v100, v101
    v_cvt_pk_bf16_f32 v227, v102, v103
    s_nop 1
    v_permlane32_swap_b32 v224, v226
    v_permlane32_swap_b32 v225, v227
    buffer_store_dwordx4 v[224:227], v11, s[28:31], 0 offen offset:128
    v_mul_f32 v104, v104, v7
    v_mul_f32 v105, v105, v7
    v_mul_f32 v106, v106, v7
    v_mul_f32 v107, v107, v7
    v_mul_f32 v108, v108, v7
    v_mul_f32 v109, v109, v7
    v_mul_f32 v110, v110, v7
    v_mul_f32 v111, v111, v7
    v_cvt_pk_bf16_f32 v228, v104, v105
    v_cvt_pk_bf16_f32 v229, v106, v107
    v_cvt_pk_bf16_f32 v230, v108, v109
    v_cvt_pk_bf16_f32 v231, v110, v111
    s_nop 1
    v_permlane32_swap_b32 v228, v230
    v_permlane32_swap_b32 v229, v231
    buffer_store_dwordx4 v[228:231], v11, s[28:31], 0 offen offset:160
    v_mul_f32 v112, v112, v7
    v_mul_f32 v113, v113, v7
    v_mul_f32 v114, v114, v7
    v_mul_f32 v115, v115, v7
    v_mul_f32 v116, v116, v7
    v_mul_f32 v117, v117, v7
    v_mul_f32 v118, v118, v7
    v_mul_f32 v119, v119, v7
    v_cvt_pk_bf16_f32 v232, v112, v113
    v_cvt_pk_bf16_f32 v233, v114, v115
    v_cvt_pk_bf16_f32 v234, v116, v117
    v_cvt_pk_bf16_f32 v235, v118, v119
    s_nop 1
    v_permlane32_swap_b32 v232, v234
    v_permlane32_swap_b32 v233, v235
    buffer_store_dwordx4 v[232:235], v11, s[28:31], 0 offen offset:192
    v_mul_f32 v120, v120, v7
    v_mul_f32 v121, v121, v7
    v_mul_f32 v122, v122, v7
    v_mul_f32 v123, v123, v7
    v_mul_f32 v124, v124, v7
    v_mul_f32 v125, v125, v7
    v_mul_f32 v126, v126, v7
    v_mul_f32 v127, v127, v7
    v_cvt_pk_bf16_f32 v236, v120, v121
    v_cvt_pk_bf16_f32 v237, v122, v123
    v_cvt_pk_bf16_f32 v238, v124, v125
    v_cvt_pk_bf16_f32 v239, v126, v127
    s_nop 1
    v_permlane32_swap_b32 v236, v238
    v_permlane32_swap_b32 v237, v239
    buffer_store_dwordx4 v[236:239], v11, s[28:31], 0 offen offset:224
    s_endpgm
L_E1:
    s_waitcnt vmcnt(0)
    s_barrier
    s_cmp_eq_u32 s63, 0
    s_cbranch_scc1 L_noo_E1
    v_mul_f32 v64, v64, v4
    v_mul_f32 v65, v65, v4
    v_mul_f32 v66, v66, v4
    v_mul_f32 v67, v67, v4
    v_mul_f32 v68, v68, v4
    v_mul_f32 v69, v69, v4
    v_mul_f32 v70, v70, v4
    v_mul_f32 v71, v71, v4
    v_mul_f32 v72, v72, v4
    v_mul_f32 v73, v73, v4
    v_mul_f32 v74, v74, v4
    v_mul_f32 v75, v75, v4
    v_mul_f32 v76, v76, v4
    v_mul_f32 v77, v77, v4
    v_mul_f32 v78, v78, v4
    v_mul_f32 v79, v79, v4
    v_mul_f32 v80, v80, v4
    v_mul_f32 v81, v81, v4
    v_mul_f32 v82, v82, v4
    v_mul_f32 v83, v83, v4
    v_mul_f32 v84, v84, v4
    v_mul_f32 v85, v85, v4
    v_mul_f32 v86, v86, v4
    v_mul_f32 v87, v87, v4
    v_mul_f32 v88, v88, v4
    v_mul_f32 v89, v89, v4
    v_mul_f32 v90, v90, v4
    v_mul_f32 v91, v91, v4
    v_mul_f32 v92, v92, v4
    v_mul_f32 v93, v93, v4
    v_mul_f32 v94, v94, v4
    v_mul_f32 v95, v95, v4
    v_mul_f32 v96, v96, v4
    v_mul_f32 v97, v97, v4
    v_mul_f32 v98, v98, v4
    v_mul_f32 v99, v99, v4
    v_mul_f32 v100, v100, v4
    v_mul_f32 v101, v101, v4
    v_mul_f32 v102, v102, v4
    v_mul_f32 v103, v103, v4
    v_mul_f32 v104, v104, v4
    v_mul_f32 v105, v105, v4
    v_mul_f32 v106, v106, v4
    v_mul_f32 v107, v107, v4
    v_mul_f32 v108, v108, v4
    v_mul_f32 v109, v109, v4
    v_mul_f32 v110, v110, v4
    v_mul_f32 v111, v111, v4
    v_mul_f32 v112, v112, v4
    v_mul_f32 v113, v113, v4
    v_mul_f32 v114, v114, v4
    v_mul_f32 v115, v115, v4
    v_mul_f32 v116, v116, v4
    v_mul_f32 v117, v117, v4
    v_mul_f32 v118, v118, v4
    v_mul_f32 v119, v119, v4
    v_mul_f32 v120, v120, v4
    v_mul_f32 v121, v121, v4
    v_mul_f32 v122, v122, v4
    v_mul_f32 v123, v123, v4
    v_mul_f32 v124, v124, v4
    v_mul_f32 v125, v125, v4
    v_mul_f32 v126, v126, v4
    v_mul_f32 v127, v127, v4
    s_mov_b32 s63, 0
    s_nop 1
L_noo_E1:
    ds_read_b64_tr_b16 v[32:33], v24 offset:49152
    ds_read_b64_tr_b16 v[34:35], v25 offset:51200
    ds_read_b64_tr_b16 v[36:37], v26 offset:49152
    ds_read_b64_tr_b16 v[38:39], v27 offset:51200
    ds_read_b64_tr_b16 v[40:41], v28 offset:49152
    ds_read_b64_tr_b16 v[42:43], v29 offset:51200
    ds_read_b64_tr_b16 v[44:45], v30 offset:49152
    ds_read_b64_tr_b16 v[46:47], v31 offset:51200
    v_mov_b32 v6, v3
    s_nop 1
    v_permlane32_swap_b32 v3, v6
    v_add_f32 v3, v3, v6
    v_rcp_f32 v7, v3
    v_and_b32 v5, 31, v1
    s_waitcnt lgkmcnt(6)
    v_mfma_f32_32x32x16_bf16 v[64:79], v[32:35], v[224:227], v[64:79]
    ds_read_b64_tr_b16 v[48:49], v24 offset:53248
    ds_read_b64_tr_b16 v[50:51], v25 offset:55296
    v_cmp_gt_i32 vcc, s78, v5
    s_waitcnt lgkmcnt(6)
    v_mfma_f32_32x32x16_bf16 v[80:95], v[36:39], v[224:227], v[80:95]
    ds_read_b64_tr_b16 v[52:53], v26 offset:53248
    ds_read_b64_tr_b16 v[54:55], v27 offset:55296
    s_waitcnt lgkmcnt(6)
    v_mfma_f32_32x32x16_bf16 v[96:111], v[40:43], v[224:227], v[96:111]
    ds_read_b64_tr_b16 v[56:57], v28 offset:53248
    ds_read_b64_tr_b16 v[58:59], v29 offset:55296
    s_waitcnt lgkmcnt(6)
    v_mfma_f32_32x32x16_bf16 v[112:127], v[44:47], v[224:227], v[112:127]
    ds_read_b64_tr_b16 v[60:61], v30 offset:53248
    ds_read_b64_tr_b16 v[62:63], v31 offset:55296
    s_waitcnt lgkmcnt(6)
    v_mfma_f32_32x32x16_bf16 v[64:79], v[48:51], v[228:231], v[64:79]
    ds_read_b64_tr_b16 v[32:33], v24 offset:57344
    ds_read_b64_tr_b16 v[34:35], v25 offset:59392
    v_mov_b32 v6, 0x7f000000
    s_waitcnt lgkmcnt(6)
    v_mfma_f32_32x32x16_bf16 v[80:95], v[52:55], v[228:231], v[80:95]
    ds_read_b64_tr_b16 v[36:37], v26 offset:57344
    ds_read_b64_tr_b16 v[38:39], v27 offset:59392
    s_waitcnt lgkmcnt(6)
    v_mfma_f32_32x32x16_bf16 v[96:111], v[56:59], v[228:231], v[96:111]
    ds_read_b64_tr_b16 v[40:41], v28 offset:57344
    ds_read_b64_tr_b16 v[42:43], v29 offset:59392
    s_waitcnt lgkmcnt(6)
    v_mfma_f32_32x32x16_bf16 v[112:127], v[60:63], v[228:231], v[112:127]
    ds_read_b64_tr_b16 v[44:45], v30 offset:57344
    ds_read_b64_tr_b16 v[46:47], v31 offset:59392
    s_waitcnt lgkmcnt(6)
    v_mfma_f32_32x32x16_bf16 v[64:79], v[32:35], v[232:235], v[64:79]
    ds_read_b64_tr_b16 v[48:49], v24 offset:61440
    ds_read_b64_tr_b16 v[50:51], v25 offset:63488
    s_nop 1
    s_waitcnt lgkmcnt(6)
    v_mfma_f32_32x32x16_bf16 v[80:95], v[36:39], v[232:235], v[80:95]
    ds_read_b64_tr_b16 v[52:53], v26 offset:61440
    ds_read_b64_tr_b16 v[54:55], v27 offset:63488
    s_waitcnt lgkmcnt(6)
    v_mfma_f32_32x32x16_bf16 v[96:111], v[40:43], v[232:235], v[96:111]
    ds_read_b64_tr_b16 v[56:57], v28 offset:61440
    ds_read_b64_tr_b16 v[58:59], v29 offset:63488
    s_waitcnt lgkmcnt(6)
    v_mfma_f32_32x32x16_bf16 v[112:127], v[44:47], v[232:235], v[112:127]
    ds_read_b64_tr_b16 v[60:61], v30 offset:61440
    ds_read_b64_tr_b16 v[62:63], v31 offset:63488
    s_waitcnt lgkmcnt(6)
    v_mfma_f32_32x32x16_bf16 v[64:79], v[48:51], v[236:239], v[64:79]
    v_cndmask_b32 v11, v6, v11, vcc
    s_waitcnt lgkmcnt(4)
    v_mfma_f32_32x32x16_bf16 v[80:95], v[52:55], v[236:239], v[80:95]
    s_waitcnt lgkmcnt(2)
    v_mfma_f32_32x32x16_bf16 v[96:111], v[56:59], v[236:239], v[96:111]
    s_waitcnt lgkmcnt(0)
    v_mfma_f32_32x32x16_bf16 v[112:127], v[60:63], v[236:239], v[112:127]
    s_nop 15
    v_mul_f32 v64, v64, v7
    v_mul_f32 v65, v65, v7
    v_mul_f32 v66, v66, v7
    v_mul_f32 v67, v67, v7
    v_mul_f32 v68, v68, v7
    v_mul_f32 v69, v69, v7
    v_mul_f32 v70, v70, v7
    v_mul_f32 v71, v71, v7
    v_cvt_pk_bf16_f32 v224, v64, v65
    v_cvt_pk_bf16_f32 v225, v66, v67
    v_cvt_pk_bf16_f32 v226, v68, v69
    v_cvt_pk_bf16_f32 v227, v70, v71
    s_nop 1
    v_permlane32_swap_b32 v224, v226
    v_permlane32_swap_b32 v225, v227
    buffer_store_dwordx4 v[224:227], v11, s[28:31], 0 offen offset:0
    v_mul_f32 v72, v72, v7
    v_mul_f32 v73, v73, v7
    v_mul_f32 v74, v74, v7
    v_mul_f32 v75, v75, v7
    v_mul_f32 v76, v76, v7
    v_mul_f32 v77, v77, v7
    v_mul_f32 v78, v78, v7
    v_mul_f32 v79, v79, v7
    v_cvt_pk_bf16_f32 v228, v72, v73
    v_cvt_pk_bf16_f32 v229, v74, v75
    v_cvt_pk_bf16_f32 v230, v76, v77
    v_cvt_pk_bf16_f32 v231, v78, v79
    s_nop 1
    v_permlane32_swap_b32 v228, v230
    v_permlane32_swap_b32 v229, v231
    buffer_store_dwordx4 v[228:231], v11, s[28:31], 0 offen offset:32
    v_mul_f32 v80, v80, v7
    v_mul_f32 v81, v81, v7
    v_mul_f32 v82, v82, v7
    v_mul_f32 v83, v83, v7
    v_mul_f32 v84, v84, v7
    v_mul_f32 v85, v85, v7
    v_mul_f32 v86, v86, v7
    v_mul_f32 v87, v87, v7
    v_cvt_pk_bf16_f32 v232, v80, v81
    v_cvt_pk_bf16_f32 v233, v82, v83
    v_cvt_pk_bf16_f32 v234, v84, v85
    v_cvt_pk_bf16_f32 v235, v86, v87
    s_nop 1
    v_permlane32_swap_b32 v232, v234
    v_permlane32_swap_b32 v233, v235
    buffer_store_dwordx4 v[232:235], v11, s[28:31], 0 offen offset:64
    v_mul_f32 v88, v88, v7
    v_mul_f32 v89, v89, v7
    v_mul_f32 v90, v90, v7
    v_mul_f32 v91, v91, v7
    v_mul_f32 v92, v92, v7
    v_mul_f32 v93, v93, v7
    v_mul_f32 v94, v94, v7
    v_mul_f32 v95, v95, v7
    v_cvt_pk_bf16_f32 v236, v88, v89
    v_cvt_pk_bf16_f32 v237, v90, v91
    v_cvt_pk_bf16_f32 v238, v92, v93
    v_cvt_pk_bf16_f32 v239, v94, v95
    s_nop 1
    v_permlane32_swap_b32 v236, v238
    v_permlane32_swap_b32 v237, v239
    buffer_store_dwordx4 v[236:239], v11, s[28:31], 0 offen offset:96
    v_mul_f32 v96, v96, v7
    v_mul_f32 v97, v97, v7
    v_mul_f32 v98, v98, v7
    v_mul_f32 v99, v99, v7
    v_mul_f32 v100, v100, v7
    v_mul_f32 v101, v101, v7
    v_mul_f32 v102, v102, v7
    v_mul_f32 v103, v103, v7
    v_cvt_pk_bf16_f32 v224, v96, v97
    v_cvt_pk_bf16_f32 v225, v98, v99
    v_cvt_pk_bf16_f32 v226, v100, v101
    v_cvt_pk_bf16_f32 v227, v102, v103
    s_nop 1
    v_permlane32_swap_b32 v224, v226
    v_permlane32_swap_b32 v225, v227
    buffer_store_dwordx4 v[224:227], v11, s[28:31], 0 offen offset:128
    v_mul_f32 v104, v104, v7
    v_mul_f32 v105, v105, v7
    v_mul_f32 v106, v106, v7
    v_mul_f32 v107, v107, v7
    v_mul_f32 v108, v108, v7
    v_mul_f32 v109, v109, v7
    v_mul_f32 v110, v110, v7
    v_mul_f32 v111, v111, v7
    v_cvt_pk_bf16_f32 v228, v104, v105
    v_cvt_pk_bf16_f32 v229, v106, v107
    v_cvt_pk_bf16_f32 v230, v108, v109
    v_cvt_pk_bf16_f32 v231, v110, v111
    s_nop 1
    v_permlane32_swap_b32 v228, v230
    v_permlane32_swap_b32 v229, v231
    buffer_store_dwordx4 v[228:231], v11, s[28:31], 0 offen offset:160
    v_mul_f32 v112, v112, v7
    v_mul_f32 v113, v113, v7
    v_mul_f32 v114, v114, v7
    v_mul_f32 v115, v115, v7
    v_mul_f32 v116, v116, v7
    v_mul_f32 v117, v117, v7
    v_mul_f32 v118, v118, v7
    v_mul_f32 v119, v119, v7
    v_cvt_pk_bf16_f32 v232, v112, v113
    v_cvt_pk_bf16_f32 v233, v114, v115
    v_cvt_pk_bf16_f32 v234, v116, v117
    v_cvt_pk_bf16_f32 v235, v118, v119
    s_nop 1
    v_permlane32_swap_b32 v232, v234
    v_permlane32_swap_b32 v233, v235
    buffer_store_dwordx4 v[232:235], v11, s[28:31], 0 offen offset:192
    v_mul_f32 v120, v120, v7
    v_mul_f32 v121, v121, v7
    v_mul_f32 v122, v122, v7
    v_mul_f32 v123, v123, v7
    v_mul_f32 v124, v124, v7
    v_mul_f32 v125, v125, v7
    v_mul_f32 v126, v126, v7
    v_mul_f32 v127, v127, v7
    v_cvt_pk_bf16_f32 v236, v120, v121
    v_cvt_pk_bf16_f32 v237, v122, v123
    v_cvt_pk_bf16_f32 v238, v124, v125
    v_cvt_pk_bf16_f32 v239, v126, v127
    s_nop 1
    v_permlane32_swap_b32 v236, v238
    v_permlane32_swap_b32 v237, v239
    buffer_store_dwordx4 v[236:239], v11, s[28:31], 0 offen offset:224
L_end:
    s_endpgm
.section .rodata,"a"
.p2align 6
.amdhsa_kernel standalone__ragged_sequences_varlen_flash_attn__ragged_kernel
  .amdhsa_next_free_vgpr 256
  .amdhsa_next_free_sgpr 102
  .amdhsa_accum_offset 256
  .amdhsa_group_segment_fixed_size 0
  .amdhsa_kernarg_size 56
  .amdhsa_user_sgpr_count 2
  .amdhsa_user_sgpr_kernarg_segment_ptr 1
  .amdhsa_system_sgpr_workgroup_id_x 1
.end_amdhsa_kernel
```
